```python
import torch

def _softmax(x, axis=-1):
    return torch.softmax(x, dim=axis)
def _gelu(x):
    return torch.nn.functional.gelu(x, approximate="tanh")
def _silu(x):
    return torch.nn.functional.silu(x)
def _sigmoid(x):
    return torch.sigmoid(x)
def _layernorm(x, axis=-1, eps=1e-5):
    m = x.mean(dim=axis, keepdim=True)
    v = x.var(dim=axis, keepdim=True, unbiased=False)
    return (x - m) / torch.sqrt(v + eps)
def _scatter_add(tgt, idx, src, axis=0):
    return tgt.clone().index_add_(axis, idx, src)
def _segment_sum(src, seg, n):
    out = torch.zeros((n,) + src.shape[1:], dtype=src.dtype)
    return out.index_add_(0, seg, src)
def _pad(x, pw):
    flat = tuple(v for pair in reversed(pw) for v in pair)
    return torch.nn.functional.pad(x, flat)

kernel_name = 'recurrent_scan__ssm_conv_h3__glu_gated_bilinear__prompt'

def setup_inputs():

    _w = (lambda a: (lambda t: t.to(torch.bfloat16) if t.is_floating_point() else t)(torch.as_tensor(a)))
    def _A_setup():
        B, S, D = 1, 2048, 512
        ks = 4
        return {
            "q": _w((lambda *s: torch.randn(*s, dtype=torch.bfloat16) * 0.05)(B, S, D)),
            "k": _w((lambda *s: torch.randn(*s, dtype=torch.bfloat16) * 0.8)(B, S, D)),
            "v": _w((lambda *s: torch.randn(*s, dtype=torch.bfloat16) * 0.8)(B, S, D)),
            "shift_k": _w((lambda *s: torch.randn(*s, dtype=torch.bfloat16) * 0.8)(D, ks) * 0.5),
            "ssm_k": _w((lambda *s: torch.randn(*s, dtype=torch.bfloat16) * 0.8)(D, S) * (1.0 / S ** 0.5)),
            "ssm_D": _w((lambda *s: torch.randn(*s, dtype=torch.bfloat16) * 0.8)(D)),
        }
    _A_in = _A_setup()

    def _B_setup():
        B, S, D, F = 1, 2048, 512, 1376
        return {
            "x": _w((lambda *s: torch.randn(*s, dtype=torch.bfloat16) * 0.05)(B, S, D)),
            "w_gate": _w((lambda *s: torch.randn(*s, dtype=torch.bfloat16) * 0.2)(D, F) * (D ** -0.5)),
            "w_up": _w((lambda *s: torch.randn(*s, dtype=torch.bfloat16) * 0.2)(D, F) * (D ** -0.5)),
            "w_down": _w((lambda *s: torch.randn(*s, dtype=torch.bfloat16) * 0.2)(F, D) * (F ** -0.5)),
        }
    _B_in = _B_setup()

    return {
        "A_q": _A_in["q"],
        "A_k": _A_in["k"],
        "A_v": _A_in["v"],
        "A_shift_k": _A_in["shift_k"],
        "A_ssm_k": _A_in["ssm_k"],
        "A_ssm_D": _A_in["ssm_D"],
        "B_x": _B_in["x"],
        "B_w_gate": _B_in["w_gate"],
        "B_w_up": _B_in["w_up"],
        "B_w_down": _B_in["w_down"],
    }

def reference(A_q, A_k, A_v, A_shift_k, A_ssm_k, A_ssm_D, B_x, B_w_gate, B_w_up, B_w_down):
    def _A_ref(q, k, v, shift_k, ssm_k, ssm_D):
        B, S, D = q.shape
        ks = shift_k.shape[-1]
        k_pad = _pad(k, ((0, 0), (ks - 1, 0), (0, 0)))
        k_shift = torch.zeros_like(k)
        for t in range(ks):
            k_shift = k_shift + k_pad[:, t:t + S, :] * shift_k[:, ks - 1 - t][None, None, :]
        kv = k_shift * v
        L = 2 * S
        kv_pad = _pad(kv, ((0, 0), (0, S), (0, 0)))
        kf_pad = _pad(ssm_k, ((0, 0), (0, S)))
        kv_f = (lambda x, axes=(-2,-1): torch.fft.rfft2(x.float(), dim=axes))(kv_pad[:, None, :, :], axes=(1, 2))
        kf_f = (lambda x, axes=(-2,-1): torch.fft.rfft2(x.float(), dim=axes))(kf_pad[:, None, :], axes=(1, 2))
        kf_f = (lambda x, *d: x.permute(*d))(kf_f, 1, 2, 0)
        y_f = kv_f * kf_f[None, :, :, :]
        y = (lambda x, s, axes=(-2,-1): torch.fft.irfft2(x, s=s, dim=axes).to(torch.bfloat16))(y_f, (1, L), axes=(1, 2))[:, 0, :S, :]
        y = y + kv * ssm_D[None, None, :]
        return q * y

    def _B_ref(x, w_gate, w_up, w_down):
        g = torch.einsum("bsd,df->bsf", x, w_gate)
        u = torch.einsum("bsd,df->bsf", x, w_up)
        h = g * u
        return torch.einsum("bsf,fd->bsd", h, w_down)

    x = A_q
    xn = _layernorm(x, axis=-1)
    s = _A_ref(xn, A_k, A_v, A_shift_k, A_ssm_k, A_ssm_D)
    g = _silu(_B_ref(xn, B_w_gate, B_w_up, B_w_down))
    return x + s * g
```

```asm
; @launch grid=(256,1,1) block=(512,1,1) lds=163840
.amdgcn_target "amdgcn-amd-amdhsa--gfx950"
.text
.globl recurrent_scan__ssm_conv_h3__glu_gated_bilinear__prompt_kernel
.p2align 8
.type recurrent_scan__ssm_conv_h3__glu_gated_bilinear__prompt_kernel,@function
recurrent_scan__ssm_conv_h3__glu_gated_bilinear__prompt_kernel:
    s_load_dwordx16 s[76:91], s[0:1], 0
    s_load_dwordx8 s[92:99], s[0:1], 64
    s_load_dwordx2 s[40:41], s[0:1], 96
    s_cmp_ge_u32 s2, 256
    s_cbranch_scc1 recurrent_scan__ssm_conv_h3__glu_gated_bilinear__prompt_kernel_end
    v_lshrrev_b32 v1, 6, v0
    v_and_b32 v0, 63, v0
    v_readfirstlane_b32 s44, v1
    s_and_b32 s45, s2, 7
    s_lshr_b32 s46, s2, 3
    s_mov_b32 s3, 0x20000
    s_mov_b32 s42, 16777216
    s_mov_b32 s43, s3
    s_and_b32 s47, s44, 3
    s_cmp_ge_u32 s44, 4
    s_cbranch_scc1 recurrent_scan__ssm_conv_h3__glu_gated_bilinear__prompt_kernel_Lw
    s_setprio 1
    s_getpc_b64 s[58:59]
recurrent_scan__ssm_conv_h3__glu_gated_bilinear__prompt_kernel_pc:
    s_lshl2_add_u32 s62, s46, s47
    s_lshl_b32 s62, s62, 8
    v_and_b32 v2, 32, v0
    v_lshl_add_u32 v2, v2, 2, s62
    v_min_u32 v2, recurrent_scan__ssm_conv_h3__glu_gated_bilinear__prompt_kernel_end-recurrent_scan__ssm_conv_h3__glu_gated_bilinear__prompt_kernel_pc-4, v2
    global_load_dword v254, v2, s[58:59]
    s_mov_b32 s6, 2097152
    s_mov_b32 s7, s3
    s_lshl_b32 s62, s45, 5
    s_add_u32 s62, s62, s46
    s_lshl_b32 s62, s62, 2
    s_add_u32 s67, s62, s47
    s_lshl_b32 s67, s67, 11
    v_lshlrev_b32 v7, 4, v0
    s_mov_b32 s10, s6
    s_mov_b32 s11, s3
    s_mov_b32 s14, s6
    s_mov_b32 s15, s3
    s_mov_b32 s18, 4096
    s_mov_b32 s19, s3
    s_and_b32 s63, s46, 3
    s_lshl2_add_u32 s55, s45, s63
    s_and_b32 s56, s46, 28
    s_lshr_b32 s56, 0x37654210, s56
    s_and_b32 s56, s56, 7
    s_lshl_b32 s64, s55, 16
    s_lshl2_add_u32 s68, s56, s47
    s_lshl_b32 s63, s56, 7
    s_add_u32 s64, s64, s63
    v_lshrrev_b32 v3, 3, v0
    v_and_b32 v2, 0x70, v7
    v_lshl_add_u32 v2, v3, 10, v2
    v_add_u32 v2, s64, v2
    v_xor_b32 v237, 0x70, v2
    v_subrev_u32 v237, 8192, v237
    v_cmp_lt_u32 vcc, 4, v3
    s_mul_i32 s63, s47, 16416
    s_lshl_b32 s24, s47, 11
    v_cndmask_b32 v237, 2.0, v237, vcc
    v_xor_b32 v236, s63, v2
    v_xor_b32 v239, 16, v236
    v_add_u32 v239, 7168, v239
    s_lshl_b32 s64, s68, 4
    v_lshrrev_b32 v4, 3, v0
    v_lshl_add_u32 v5, v4, 1, s64
    v_lshlrev_b32 v238, 3, v5
    s_waitcnt lgkmcnt(0)
    s_mov_b64 s[4:5], s[76:77]
    buffer_load_dwordx4 v[148:151], v7, s[4:7], s67 offen offset:0
    buffer_load_dwordx4 v[152:155], v7, s[4:7], s67 offen offset:1024
    s_load_dword s48, s[40:41], 0
    s_load_dword s50, s[86:87], s62
    s_mov_b64 s[8:9], s[78:79]
    s_mov_b64 s[12:13], s[80:81]
    s_mov_b64 s[16:17], s[82:83]
    s_branch recurrent_scan__ssm_conv_h3__glu_gated_bilinear__prompt_kernel_Cw
recurrent_scan__ssm_conv_h3__glu_gated_bilinear__prompt_kernel_Lw:
    s_and_b32 s62, s46, 3
    s_and_b32 s63, s45, 6
    s_lshl1_add_u32 s51, s63, s62
    s_and_b32 s64, s45, 1
    s_mul_i32 s65, s64, 7
    s_lshr_b32 s66, s46, 2
    s_add_u32 s52, s65, s66
    s_lshr_b32 s62, s62, 1
    s_xor_b32 s62, s62, s64
    s_cmp_lt_u32 s66, 7
    s_cselect_b32 s52, s52, 14
    s_cselect_b32 s53, 0, s62
    s_mov_b32 s6, 2097152
    s_mov_b32 s7, s3
    s_mov_b32 s26, 1411072
    s_mov_b32 s27, s3
    s_mov_b32 s30, s26
    s_mov_b32 s31, s3
    s_movk_i32 s67, 2048
    v_lshlrev_b32 v11, 4, v0
    s_mul_i32 s62, s52, 192
    s_cmp_eq_u32 s52, 14
    s_cselect_b32 s64, 0.5, -960
    s_addk_i32 s62, 2048
    s_movk_i32 s63, 2752
    v_lshrrev_b32 v16, 2, v0
    v_lshl_add_u32 v16, s47, 4, v16
    v_and_b32 v17, 48, v11
    v_and_b32 v18, 32, v0
    v_xor_b32 v17, v17, v18
    v_mad_u32_u24 v16, v16, s63, v17
    v_add_u32 v1, s62, v16
    v_add_u32 v2, s64, v1
    v_add_u32 v3, s64, v2
    s_lshl2_add_u32 s62, s51, s47
    s_lshl_b32 s62, s62, 15
    v_lshrrev_b32 v16, 3, v0
    v_lshrrev_b32 v17, 4, v0
    v_xor_b32 v17, v17, v0
    v_and_b32 v17, 7, v17
    v_lshlrev_b32 v17, 4, v17
    v_lshl_add_u32 v7, v16, 10, v17
    v_add_u32 v7, s62, v7
    v_xor_b32 v8, 64, v7
    v_add_u32 v8, 7168, v8
    v_add_u32 v9, 14336, v7
    v_add_u32 v10, 14336, v8
    s_lshl_b32 s69, s47, 12
    s_mul_i32 s70, s47, -1024
    s_add_u32 s70, s70, 16384
    s_and_b32 s62, s45, 1
    s_and_b32 s63, s45, 6
    s_lshl2_add_u32 s54, s62, s63
    s_and_b32 s63, s46, 1
    s_add_u32 s54, s54, s63
    s_lshl1_add_u32 s68, s63, 1
    s_waitcnt lgkmcnt(0)
    s_mov_b64 s[4:5], s[76:77]
    s_sub_u32 s24, s90, s67
    s_subb_u32 s25, s91, 0
    s_sub_u32 s28, s92, s67
    s_subb_u32 s29, s93, 0
    s_load_dword s48, s[40:41], 0
    s_cmp_lg_u32 s53, 0
    s_cbranch_scc1 recurrent_scan__ssm_conv_h3__glu_gated_bilinear__prompt_kernel_Lspare
    s_and_b32 s54, s54, 7
    s_mov_b32 m0, s69
    s_lshl_b32 s71, s54, 7
    s_mul_i32 s72, s54, 176128
    buffer_load_dwordx4 v7, s[4:7], s71 offen offset:0 lds
    buffer_load_dwordx4 v8, s[4:7], s71 offen offset:1024 lds
    buffer_load_dwordx4 v9, s[4:7], s71 offen offset:2048 lds
    buffer_load_dwordx4 v10, s[4:7], s71 offen offset:3072 lds
    s_add_u32 m0, m0, s70
    s_xor_b32 s54, s54, 1
    buffer_load_dwordx4 v1, s[24:27], s72 offen offset:0 lds
    buffer_load_dwordx4 v2, s[24:27], s72 offen offset:1024 lds
    buffer_load_dwordx4 v3, s[24:27], s72 offen offset:2048 lds
    s_add_u32 m0, m0, 12288
    s_add_u32 s69, s69, 40960
    buffer_load_dwordx4 v1, s[28:31], s72 offen offset:0 lds
    buffer_load_dwordx4 v2, s[28:31], s72 offen offset:1024 lds
    buffer_load_dwordx4 v3, s[28:31], s72 offen offset:2048 lds
    s_cmp_ge_u32 s69, 122880
    s_cselect_b32 s62, 122880, 0
    s_sub_u32 s69, s69, s62
    s_and_b32 s54, s54, 7
    s_mov_b32 m0, s69
    s_lshl_b32 s71, s54, 7
    s_mul_i32 s72, s54, 176128
recurrent_scan__ssm_conv_h3__glu_gated_bilinear__prompt_kernel_Lsetup:
    s_mov_b32 s22, 2097152
    s_mov_b32 s23, s3
    s_mov_b64 s[20:21], s[84:85]
    s_mov_b32 s34, 1409024
    s_mov_b32 s35, s3
    s_mov_b64 s[32:33], s[94:95]
    s_mov_b32 s38, 2097152
    s_mov_b32 s39, s3
    s_mov_b64 s[36:37], s[96:97]
    s_and_b32 s62, s46, 3
    s_lshl_b32 s55, s45, 2
    s_add_u32 s55, s55, s62
    s_and_b32 s56, s46, 28
    s_lshr_b32 s56, 0x37654210, s56
    s_and_b32 s56, s56, 7
    s_waitcnt lgkmcnt(0)
    s_add_u32 s48, s48, 1
    s_mul_i32 s49, s48, 0x9E3779B1
    s_add_u32 s49, s49, 0x7F4A7C15
    s_lshl_b32 s65, s45, 5
    s_add_u32 s65, s65, s46
    s_lshl2_add_u32 s65, s65, s47
    s_lshl_b32 s65, s65, 11
    v_add_u32 v31, s65, v11
    s_cmp_lg_u32 s53, 0
    s_cbranch_scc1 recurrent_scan__ssm_conv_h3__glu_gated_bilinear__prompt_kernel_setB
    buffer_load_dwordx4 v7, s[4:7], s71 offen offset:0 lds
    buffer_load_dwordx4 v8, s[4:7], s71 offen offset:1024 lds
    buffer_load_dwordx4 v9, s[4:7], s71 offen offset:2048 lds
    buffer_load_dwordx4 v10, s[4:7], s71 offen offset:3072 lds
    s_add_u32 m0, m0, s70
    s_or_b32 s54, s54, 1
    s_add_u32 s54, s54, 1
    buffer_load_dwordx4 v1, s[24:27], s72 offen offset:0 lds
    buffer_load_dwordx4 v2, s[24:27], s72 offen offset:1024 lds
    buffer_load_dwordx4 v3, s[24:27], s72 offen offset:2048 lds
    s_barrier
    s_add_u32 m0, m0, 12288
    s_add_u32 s69, s69, 40960
    buffer_load_dwordx4 v1, s[28:31], s72 offen offset:0 lds
    buffer_load_dwordx4 v2, s[28:31], s72 offen offset:1024 lds
    buffer_load_dwordx4 v3, s[28:31], s72 offen offset:2048 lds
    s_cmp_ge_u32 s69, 122880
    s_cselect_b32 s62, 122880, 0
    s_sub_u32 s69, s69, s62
    s_and_b32 s54, s54, 7
    s_mov_b32 m0, s69
    s_lshl_b32 s71, s54, 7
    s_mul_i32 s72, s54, 176128
    buffer_load_dwordx4 v7, s[4:7], s71 offen offset:0 lds
    buffer_load_dwordx4 v8, s[4:7], s71 offen offset:1024 lds
    s_waitcnt vmcnt(12)
    s_barrier
    buffer_load_dwordx4 v9, s[4:7], s71 offen offset:2048 lds
    buffer_load_dwordx4 v10, s[4:7], s71 offen offset:3072 lds
    s_add_u32 m0, m0, s70
    s_add_u32 s54, s54, 1
    buffer_load_dwordx4 v1, s[24:27], s72 offen offset:0 lds
    buffer_load_dwordx4 v2, s[24:27], s72 offen offset:1024 lds
    buffer_load_dwordx4 v3, s[24:27], s72 offen offset:2048 lds
    s_add_u32 m0, m0, 12288
    s_add_u32 s69, s69, 40960
    buffer_load_dwordx4 v1, s[28:31], s72 offen offset:0 lds
    buffer_load_dwordx4 v2, s[28:31], s72 offen offset:1024 lds
    buffer_load_dwordx4 v3, s[28:31], s72 offen offset:2048 lds
    s_cmp_ge_u32 s69, 122880
    s_cselect_b32 s62, 122880, 0
    s_sub_u32 s69, s69, s62
    s_waitcnt vmcnt(10)
    s_barrier
    buffer_load_dwordx4 v[160:163], v31, s[20:23], 0 offen offset:0
    buffer_load_dwordx2 v[164:165], v31, s[20:23], 0 offen offset:16
    buffer_load_dwordx4 v[168:171], v31, s[20:23], 0 offen offset:1024
    buffer_load_dwordx2 v[172:173], v31, s[20:23], 0 offen offset:1040
    s_and_b32 s54, s54, 7
    s_mov_b32 m0, s69
    s_lshl_b32 s71, s54, 7
    s_mul_i32 s72, s54, 176128
    buffer_load_dwordx4 v7, s[4:7], s71 offen offset:0 lds
    buffer_load_dwordx4 v8, s[4:7], s71 offen offset:1024 lds
    buffer_load_dwordx4 v9, s[4:7], s71 offen offset:2048 lds
    buffer_load_dwordx4 v10, s[4:7], s71 offen offset:3072 lds
    s_add_u32 m0, m0, s70
    s_add_u32 s54, s54, 1
    buffer_load_dwordx4 v1, s[24:27], s72 offen offset:0 lds
    buffer_load_dwordx4 v2, s[24:27], s72 offen offset:1024 lds
    buffer_load_dwordx4 v3, s[24:27], s72 offen offset:2048 lds
    s_add_u32 m0, m0, 12288
    s_add_u32 s69, s69, 40960
    buffer_load_dwordx4 v1, s[28:31], s72 offen offset:0 lds
    buffer_load_dwordx4 v2, s[28:31], s72 offen offset:1024 lds
    buffer_load_dwordx4 v3, s[28:31], s72 offen offset:2048 lds
    s_cmp_ge_u32 s69, 122880
    s_cselect_b32 s62, 122880, 0
    s_sub_u32 s69, s69, s62
    s_waitcnt vmcnt(14)
recurrent_scan__ssm_conv_h3__glu_gated_bilinear__prompt_kernel_setB:
    s_mul_i32 s62, s47, 360448
    s_lshl_b32 s63, s56, 7
    s_add_u32 s62, s62, s63
    v_bfe_u32 v16, v0, 2, 2
    v_lshrrev_b32 v17, 5, v0
    v_lshl_add_u32 v18, v17, 2, v16
    v_bfe_u32 v19, v0, 4, 1
    v_and_b32 v20, 3, v0
    v_lshlrev_b32 v21, 10, v18
    v_lshl_add_u32 v21, v19, 6, v21
    v_lshl_add_u32 v21, v20, 4, v21
    v_and_b32 v18, 32, v0
    v_xor_b32 v21, v21, v18
    v_add_u32 v240, s62, v21
    s_movk_i32 s62, 7168
    v_add_u32 v241, s62, v240
    v_add_u32 v242, s62, v241
    v_add_u32 v243, s62, v242
    s_lshl_b32 s0, s47, 13
    s_and_b32 s62, s47, 1
    s_lshr_b32 s63, s47, 1
    s_lshl_b32 s64, s62, 12
    s_mul_i32 s65, s63, 40960
    s_add_u32 s1, s64, s65
    s_add_u32 s1, s1, 32768
    v_lshlrev_b32 v18, 11, v17
    v_lshl_add_u32 v18, v19, 9, v18
    v_lshl_add_u32 v21, v16, 6, v18
    v_lshl_add_u32 v21, v19, 5, v21
    v_lshl_add_u32 v21, v20, 3, v21
    v_add_u32 v254, s1, v21
    v_add_u32 v252, s0, v21
    v_add_u32 v253, 81920, v252
    v_xor_b32 v238, 32, v252
    v_xor_b32 v239, 32, v253
    v_xor_b32 v255, 32, v254
    v_and_b32 v21, 0xf0, v11
    v_add_u32 v18, v18, v21
    s_lshl_b32 s64, s62, 11
    s_mul_i32 s65, s63, 4608
    s_add_u32 s75, s65, s64
    s_lshl_b32 s66, s62, 8
    s_add_u32 s65, s65, s66
    s_add_u32 s65, s65, 121344
    v_lshrrev_b32 v24, 2, v11
    v_add_u32 v24, s65, v24
    v_mov_b32 v27, 0
    s_lshl1_add_u32 s65, s52, s63
    s_lshl_b32 s65, s65, 1
    s_lshl1_add_u32 s65, s65, s62
    s_lshl_b32 s65, s65, 11
    s_mul_i32 s50, s63, 16640
    s_add_u32 s50, s50, s64
    v_add_u32 v22, s65, v11
    v_add_u32 v22, 524288, v22
    s_lshl2_add_u32 s65, s51, s47
    s_lshl_b32 s65, s65, 9
    v_add_u32 v23, s65, v11
    v_add_u32 v23, 65536, v23
    v_add_u32 v25, 1048576, v31
    s_mul_i32 s65, s63, 16640
    s_add_u32 s65, s65, s64
    s_add_u32 s65, s65, 130560
    v_add_u32 v36, s65, v11
    s_lshr_b32 s65, s46, 3
    s_lshl2_add_u32 s65, s45, s65
    s_lshl2_add_u32 s65, s65, s47
    s_lshl_b32 s65, s65, 10
    s_add_u32 s65, s65, 262144
    v_and_b32 v26, 0x380, v11
    v_add_u32 v26, s65, v26
    s_lshl_b32 s62, s47, 2
    s_add_u32 s62, s62, 151328
    v_mov_b32 v250, s62
    v_mov_b32 v251, 1
    s_mov_b32 s8, 0
    s_movk_i32 s63, 4096
    s_add_u32 s9, s8, s63
    s_add_u32 s10, s9, s63
    s_add_u32 s11, s10, s63
    s_add_u32 s12, s11, s63
    s_add_u32 s13, s12, s63
    s_add_u32 s14, s13, s63
    s_add_u32 s15, s14, s63
    s_add_u32 s16, s15, s63
    s_add_u32 s17, s16, s63
    s_add_u32 s18, s17, s63
    s_mul_i32 s62, s47, 22
    s_mul_i32 s63, s62, 43
    s_lshr_b32 s63, s63, 7
    v_lshrrev_b32 v16, 3, v0
    v_add_u32 v16, s63, v16
    v_min_u32 v16, 28, v16
    v_lshlrev_b32 v16, 7, v16
    s_lshl_b32 s63, s55, 12
    s_add_u32 s63, s63, 393216
    v_add_u32 v232, s63, v16
    s_mul_i32 s63, s55, 86
    s_add_u32 s63, s63, s62
    s_lshl_b32 s63, s63, 11
    s_add_u32 s63, s63, 3145728
    v_add_u32 v230, s63, v18
    v_add_u32 v231, 1024, v230
    v_and_b32 v16, 15, v0
    v_lshrrev_b32 v17, 4, v0
    v_xor_b32 v17, v17, v0
    v_and_b32 v17, 7, v17
    v_lshlrev_b32 v17, 4, v17
    v_lshl_add_u32 v16, v16, 8, v17
    v_add_u32 v234, s0, v16
    v_xor_b32 v235, 64, v234
    s_cmp_eq_u32 s47, 3
    s_cselect_b32 s63, 40960, -1
    s_brev_b32 s64, 16
    s_cmp_eq_u32 s18, s63
    s_cselect_b32 s18, s64, s18
    s_lshl3_add_u32 s62, s55, s44
    s_lshl_b32 s62, s62, 3
    v_lshrrev_b32 v16, 3, v0
    v_and_b32 v17, 7, v0
    v_add_u32 v249, s62, v16
    v_lshlrev_b32 v248, 4, v17
    v_lshl_add_u32 v248, v249, 10, v248
    s_lshl_b32 s62, s56, 7
    v_add_u32 v248, s62, v248
    v_lshlrev_b32 v249, 4, v249
    v_add_u32 v249, 65536, v249
    s_lshr_b32 s62, s44, 2
    s_mul_i32 s62, s62, 40960
    s_lshl_b32 s63, s47, 11
    s_add_u32 s62, s62, s63
    v_lshlrev_b32 v18, 1, v17
    v_xor_b32 v18, v18, v16
    v_lshlrev_b32 v18, 4, v18
    v_lshl_add_u32 v18, v16, 8, v18
    v_add_u32 v224, s62, v18
    v_xor_b32 v225, 16, v224
    v_lshrrev_b32 v18, 2, v17
    v_mul_u32_u24 v226, 4608, v18
    v_bfe_u32 v18, v0, 1, 1
    v_mul_u32_u24 v18, 2176, v18
    v_add_u32 v226, v226, v18
    v_and_b32 v18, 1, v0
    v_lshl_add_u32 v226, v18, 4, v226
    v_lshl_add_u32 v226, v16, 5, v226
    s_lshl_b32 s62, s44, 8
    s_add_u32 s62, s62, 121344
    v_add_u32 v226, s62, v226
    v_mov_b32 v228, 1.0
    v_lshrrev_b32 v16, 3, v0
    v_and_b32 v16, 3, v16
    v_mul_u32_u24 v16, 4160, v16
    v_and_b32 v17, 7, v0
    v_lshl_add_u32 v16, v17, 2, v16
    s_lshr_b32 s62, s47, 1
    s_mul_i32 s62, s62, 16640
    s_add_u32 s62, s62, 130560
    v_add_u32 v37, s62, v16
    s_cmp_lg_u32 s53, 0
    s_cbranch_scc1 recurrent_scan__ssm_conv_h3__glu_gated_bilinear__prompt_kernel_wdpf
    s_barrier
    s_and_b32 s54, s54, 7
    s_mov_b32 m0, s69
    s_lshl_b32 s71, s54, 7
    s_mul_i32 s72, s54, 176128
    buffer_load_dwordx4 v7, s[4:7], s71 offen offset:0 lds
    buffer_load_dwordx4 v8, s[4:7], s71 offen offset:1024 lds
    buffer_load_dwordx4 v9, s[4:7], s71 offen offset:2048 lds
    buffer_load_dwordx4 v10, s[4:7], s71 offen offset:3072 lds
    s_add_u32 m0, m0, s70
    s_add_u32 s54, s54, 1
    buffer_load_dwordx4 v1, s[24:27], s72 offen offset:0 lds
    buffer_load_dwordx4 v2, s[24:27], s72 offen offset:1024 lds
    buffer_load_dwordx4 v3, s[24:27], s72 offen offset:2048 lds
    s_add_u32 m0, m0, 12288
    s_add_u32 s69, s69, 40960
    buffer_load_dwordx4 v1, s[28:31], s72 offen offset:0 lds
    buffer_load_dwordx4 v2, s[28:31], s72 offen offset:1024 lds
    buffer_load_dwordx4 v3, s[28:31], s72 offen offset:2048 lds
    s_cmp_ge_u32 s69, 122880
    s_cselect_b32 s62, 122880, 0
    s_sub_u32 s69, s69, s62
    s_waitcnt vmcnt(10)
    s_barrier
    s_and_b32 s54, s54, 7
    s_mov_b32 m0, s69
    s_lshl_b32 s71, s54, 7
    s_mul_i32 s72, s54, 176128
    buffer_load_dwordx4 v7, s[4:7], s71 offen offset:0 lds
    buffer_load_dwordx4 v8, s[4:7], s71 offen offset:1024 lds
    buffer_load_dwordx4 v9, s[4:7], s71 offen offset:2048 lds
    buffer_load_dwordx4 v10, s[4:7], s71 offen offset:3072 lds
    s_add_u32 m0, m0, s70
    s_add_u32 s54, s54, 1
    buffer_load_dwordx4 v1, s[24:27], s72 offen offset:0 lds
    buffer_load_dwordx4 v2, s[24:27], s72 offen offset:1024 lds
    buffer_load_dwordx4 v3, s[24:27], s72 offen offset:2048 lds
    s_add_u32 m0, m0, 12288
    s_add_u32 s69, s69, 40960
    buffer_load_dwordx4 v1, s[28:31], s72 offen offset:0 lds
    buffer_load_dwordx4 v2, s[28:31], s72 offen offset:1024 lds
    buffer_load_dwordx4 v3, s[28:31], s72 offen offset:2048 lds
    s_cmp_ge_u32 s69, 122880
    s_cselect_b32 s62, 122880, 0
    s_sub_u32 s69, s69, s62
    s_waitcnt vmcnt(10)
    s_barrier
    s_add_u32 m0, s50, 134752
    s_lshl_b32 s62, s47, 9
    buffer_load_dwordx4 v22, s[40:43], 0 offen offset:0 sc1 lds
    buffer_load_dwordx4 v22, s[40:43], 0 offen offset:1024 sc1 lds
    s_add_u32 m0, s62, 122880
    s_mov_b32 exec_hi, 0
    buffer_load_dwordx4 v23, s[40:43], 0 offen sc1 lds
    s_mov_b64 exec, -1
    buffer_load_dwordx2 v[28:29], v26, s[40:43], 0 offen sc1
    s_and_b32 s54, s54, 7
    s_mov_b32 m0, s69
    s_lshl_b32 s71, s54, 7
    s_mul_i32 s72, s54, 176128
    buffer_load_dwordx4 v7, s[4:7], s71 offen offset:0 lds
    buffer_load_dwordx4 v8, s[4:7], s71 offen offset:1024 lds
    buffer_load_dwordx4 v9, s[4:7], s71 offen offset:2048 lds
    buffer_load_dwordx4 v10, s[4:7], s71 offen offset:3072 lds
    s_add_u32 m0, m0, s70
    s_add_u32 s54, s54, 1
    buffer_load_dwordx4 v1, s[24:27], s72 offen offset:0 lds
    buffer_load_dwordx4 v2, s[24:27], s72 offen offset:1024 lds
    s_waitcnt vmcnt(10)
    s_barrier
    buffer_load_dwordx4 v3, s[24:27], s72 offen offset:2048 lds
    s_add_u32 m0, m0, 12288
    s_add_u32 s69, s69, 40960
    buffer_load_dwordx4 v1, s[28:31], s72 offen offset:0 lds
    buffer_load_dwordx4 v2, s[28:31], s72 offen offset:1024 lds
    buffer_load_dwordx4 v3, s[28:31], s72 offen offset:2048 lds
    s_cmp_ge_u32 s69, 122880
    s_cselect_b32 s62, 122880, 0
    s_sub_u32 s69, s69, s62
    s_and_b32 s54, s54, 7
    s_mov_b32 m0, s69
    s_lshl_b32 s71, s54, 7
    s_mul_i32 s72, s54, 176128
    buffer_load_dwordx4 v7, s[4:7], s71 offen offset:0 lds
    buffer_load_dwordx4 v8, s[4:7], s71 offen offset:1024 lds
    buffer_load_dwordx4 v9, s[4:7], s71 offen offset:2048 lds
    buffer_load_dwordx4 v10, s[4:7], s71 offen offset:3072 lds
    s_add_u32 m0, m0, s70
    s_add_u32 s54, s54, 1
    buffer_load_dwordx4 v1, s[24:27], s72 offen offset:0 lds
    buffer_load_dwordx4 v2, s[24:27], s72 offen offset:1024 lds
    buffer_load_dwordx4 v3, s[24:27], s72 offen offset:2048 lds
    s_waitcnt vmcnt(7)
    s_barrier
    s_add_u32 m0, m0, 12288
    s_add_u32 s69, s69, 40960
    buffer_load_dwordx4 v1, s[28:31], s72 offen offset:0 lds
    buffer_load_dwordx4 v2, s[28:31], s72 offen offset:1024 lds
    buffer_load_dwordx4 v3, s[28:31], s72 offen offset:2048 lds
    s_cmp_ge_u32 s69, 122880
    s_cselect_b32 s62, 122880, 0
    s_sub_u32 s69, s69, s62
recurrent_scan__ssm_conv_h3__glu_gated_bilinear__prompt_kernel_Ljoin:
    ds_write_b32 v37, v27
    s_waitcnt lgkmcnt(0)
    s_add_u32 m0, s0, 81920
    s_lshl_b32 s62, s8, 3
    buffer_load_dwordx4 v240, s[32:35], s62 offen offset:0 lds
    buffer_load_dwordx4 v241, s[32:35], s62 offen offset:1024 lds
    buffer_load_dwordx4 v242, s[32:35], s62 offen offset:2048 lds
    buffer_load_dwordx4 v243, s[32:35], s62 offen offset:3072 lds
    s_add_u32 m0, s0, 86016
    s_lshl_b32 s62, s9, 3
    buffer_load_dwordx4 v240, s[32:35], s62 offen offset:0 lds
    buffer_load_dwordx4 v241, s[32:35], s62 offen offset:1024 lds
    buffer_load_dwordx4 v242, s[32:35], s62 offen offset:2048 lds
    buffer_load_dwordx4 v243, s[32:35], s62 offen offset:3072 lds
    s_waitcnt vmcnt(8)
    s_mov_b32 s57, 400000
    s_branch recurrent_scan__ssm_conv_h3__glu_gated_bilinear__prompt_kernel_pc2
recurrent_scan__ssm_conv_h3__glu_gated_bilinear__prompt_kernel_pl1:
    buffer_load_dwordx2 v[28:29], v26, s[40:43], 0 offen sc1
    s_waitcnt vmcnt(0)
recurrent_scan__ssm_conv_h3__glu_gated_bilinear__prompt_kernel_pc2:
    v_cmp_ne_u32 vcc, s48, v28
    v_cmp_ne_u32 s[58:59], s49, v29
    s_nop 1
    s_or_b64 vcc, vcc, s[58:59]
    s_cbranch_scc0 recurrent_scan__ssm_conv_h3__glu_gated_bilinear__prompt_kernel_pd3
    s_sleep 8
    s_sub_u32 s57, s57, 1
    s_cbranch_scc0 recurrent_scan__ssm_conv_h3__glu_gated_bilinear__prompt_kernel_pl1
recurrent_scan__ssm_conv_h3__glu_gated_bilinear__prompt_kernel_pd3:
    s_barrier
    s_add_u32 m0, s75, 121856
    ds_write_b32 v24, v27
    buffer_load_dwordx4 v25, s[40:43], 0 offen offset:0 sc1 lds
    buffer_load_dwordx4 v25, s[40:43], 0 offen offset:1024 sc1 lds
    s_add_u32 m0, s0, 0
    s_lshl_b32 s62, s14, 3
    buffer_load_dwordx4 v240, s[32:35], s62 offen offset:0 lds
    buffer_load_dwordx4 v241, s[32:35], s62 offen offset:1024 lds
    buffer_load_dwordx4 v242, s[32:35], s62 offen offset:2048 lds
    buffer_load_dwordx4 v243, s[32:35], s62 offen offset:3072 lds
    s_add_u32 m0, s0, 4096
    s_lshl_b32 s62, s15, 3
    buffer_load_dwordx4 v240, s[32:35], s62 offen offset:0 lds
    buffer_load_dwordx4 v241, s[32:35], s62 offen offset:1024 lds
    buffer_load_dwordx4 v242, s[32:35], s62 offen offset:2048 lds
    buffer_load_dwordx4 v243, s[32:35], s62 offen offset:3072 lds
    ds_write_b128 v36, v[160:163] offset:32
    v_alignbit_b32 v176, v161, v160, 16
    v_alignbit_b32 v177, v162, v161, 16
    v_alignbit_b32 v178, v163, v162, 16
    v_alignbit_b32 v179, v164, v163, 16
    v_alignbit_b32 v187, v165, v164, 16
    ds_write_b128 v36, v[176:179] offset:4192
    v_mov_b32 v180, v161
    v_mov_b32 v181, v162
    v_mov_b32 v182, v163
    v_mov_b32 v183, v164
    ds_write_b128 v36, v[180:183] offset:8352
    v_mov_b32 v184, v177
    v_mov_b32 v185, v178
    v_mov_b32 v186, v179
    ds_write_b128 v36, v[184:187] offset:12512
    s_bitcmp1_b32 s47, 0
    s_cbranch_scc1 recurrent_scan__ssm_conv_h3__glu_gated_bilinear__prompt_kernel_hz4
    v_lshlrev_b32 v204, 16, v160
    s_mov_b64 exec, 1
    ds_write_b32 v36, v204 offset:4188
    ds_write_b32 v36, v160 offset:8348
    ds_write_b32 v36, v204 offset:12504
    ds_write_b32 v36, v176 offset:12508
    s_mov_b64 exec, -1
recurrent_scan__ssm_conv_h3__glu_gated_bilinear__prompt_kernel_hz4:
    ds_write_b128 v36, v[168:171] offset:1056
    v_alignbit_b32 v188, v169, v168, 16
    v_alignbit_b32 v189, v170, v169, 16
    v_alignbit_b32 v190, v171, v170, 16
    v_alignbit_b32 v191, v172, v171, 16
    v_alignbit_b32 v199, v173, v172, 16
    ds_write_b128 v36, v[188:191] offset:5216
    v_mov_b32 v192, v169
    v_mov_b32 v193, v170
    v_mov_b32 v194, v171
    v_mov_b32 v195, v172
    ds_write_b128 v36, v[192:195] offset:9376
    v_mov_b32 v196, v189
    v_mov_b32 v197, v190
    v_mov_b32 v198, v191
    ds_write_b128 v36, v[196:199] offset:13536
    s_waitcnt vmcnt(8)
    ds_write_b32 v250, v251 offset:0
    v_and_b32 v12, 3, v0
    v_lshlrev_b32 v12, 2, v12
    v_add_u32 v12, 159648, v12
    s_mov_b32 s57, 3200000
recurrent_scan__ssm_conv_h3__glu_gated_bilinear__prompt_kernel_fl5:
    ds_read_b32 v13, v12
    s_waitcnt lgkmcnt(0)
    v_cmp_ne_u32 vcc, 1, v13
    s_nop 1
    s_cmp_eq_u64 vcc, 0
    s_cbranch_scc1 recurrent_scan__ssm_conv_h3__glu_gated_bilinear__prompt_kernel_fd6
    s_sleep 1
    s_sub_u32 s57, s57, 1
    s_cbranch_scc0 recurrent_scan__ssm_conv_h3__glu_gated_bilinear__prompt_kernel_fl5
recurrent_scan__ssm_conv_h3__glu_gated_bilinear__prompt_kernel_fd6:
    s_setprio 2
    ds_read_b64_tr_b16 v[80:81], v253 offset:0
    ds_read_b64_tr_b16 v[82:83], v253 offset:1024
    ds_read_b64_tr_b16 v[84:85], v239 offset:0
    ds_read_b64_tr_b16 v[86:87], v239 offset:1024
    ds_read_b64_tr_b16 v[88:89], v253 offset:256
    ds_read_b64_tr_b16 v[90:91], v253 offset:1280
    ds_read_b64_tr_b16 v[92:93], v239 offset:256
    ds_read_b64_tr_b16 v[94:95], v239 offset:1280
    ds_read_b64_tr_b16 v[96:97], v253 offset:4096
    ds_read_b64_tr_b16 v[98:99], v253 offset:5120
    ds_read_b64_tr_b16 v[100:101], v239 offset:4096
    ds_read_b64_tr_b16 v[102:103], v239 offset:5120
    ds_read_b64_tr_b16 v[104:105], v253 offset:4352
    ds_read_b64_tr_b16 v[106:107], v253 offset:5376
    ds_read_b64_tr_b16 v[108:109], v239 offset:4352
    ds_read_b64_tr_b16 v[110:111], v239 offset:5376
    s_waitcnt lgkmcnt(0)
    s_add_u32 m0, s0, 81920
    s_lshl_b32 s62, s10, 3
    buffer_load_dwordx4 v240, s[32:35], s62 offen offset:0 lds
    buffer_load_dwordx4 v241, s[32:35], s62 offen offset:1024 lds
    buffer_load_dwordx4 v242, s[32:35], s62 offen offset:2048 lds
    buffer_load_dwordx4 v243, s[32:35], s62 offen offset:3072 lds
    s_add_u32 m0, s0, 86016
    s_lshl_b32 s62, s11, 3
    buffer_load_dwordx4 v240, s[32:35], s62 offen offset:0 lds
    buffer_load_dwordx4 v241, s[32:35], s62 offen offset:1024 lds
    buffer_load_dwordx4 v242, s[32:35], s62 offen offset:2048 lds
    buffer_load_dwordx4 v243, s[32:35], s62 offen offset:3072 lds
    s_add_u32 m0, s0, 40960
    s_lshl_b32 s62, s16, 3
    buffer_load_dwordx4 v240, s[32:35], s62 offen offset:0 lds
    buffer_load_dwordx4 v241, s[32:35], s62 offen offset:1024 lds
    buffer_load_dwordx4 v242, s[32:35], s62 offen offset:2048 lds
    buffer_load_dwordx4 v243, s[32:35], s62 offen offset:3072 lds
    s_add_u32 m0, s0, 45056
    s_lshl_b32 s62, s17, 3
    buffer_load_dwordx4 v240, s[32:35], s62 offen offset:0 lds
    buffer_load_dwordx4 v241, s[32:35], s62 offen offset:1024 lds
    buffer_load_dwordx4 v242, s[32:35], s62 offen offset:2048 lds
    buffer_load_dwordx4 v243, s[32:35], s62 offen offset:3072 lds
    s_mov_b32 m0, s1
    s_lshl_b32 s62, s18, 3
    buffer_load_dwordx4 v240, s[32:35], s62 offen offset:0 lds
    buffer_load_dwordx4 v241, s[32:35], s62 offen offset:1024 lds
    buffer_load_dwordx4 v242, s[32:35], s62 offen offset:2048 lds
    buffer_load_dwordx4 v243, s[32:35], s62 offen offset:3072 lds
    s_waitcnt vmcnt(12)
    ds_read_b64_tr_b16 v[112:113], v253 offset:0
    ds_read_b64_tr_b16 v[114:115], v253 offset:1024
    ds_read_b64_tr_b16 v[116:117], v239 offset:0
    ds_read_b64_tr_b16 v[118:119], v239 offset:1024
    ds_read_b64_tr_b16 v[120:121], v253 offset:256
    ds_read_b64_tr_b16 v[122:123], v253 offset:1280
    ds_read_b64_tr_b16 v[124:125], v239 offset:256
    ds_read_b64_tr_b16 v[126:127], v239 offset:1280
    ds_read_b64_tr_b16 v[128:129], v253 offset:4096
    ds_read_b64_tr_b16 v[130:131], v253 offset:5120
    ds_read_b64_tr_b16 v[132:133], v239 offset:4096
    ds_read_b64_tr_b16 v[134:135], v239 offset:5120
    ds_read_b64_tr_b16 v[136:137], v253 offset:4352
    ds_read_b64_tr_b16 v[138:139], v253 offset:5376
    ds_read_b64_tr_b16 v[140:141], v239 offset:4352
    ds_read_b64_tr_b16 v[142:143], v239 offset:5376
    s_waitcnt lgkmcnt(0)
    s_add_u32 m0, s0, 81920
    s_lshl_b32 s62, s12, 3
    buffer_load_dwordx4 v240, s[32:35], s62 offen offset:0 lds
    buffer_load_dwordx4 v241, s[32:35], s62 offen offset:1024 lds
    buffer_load_dwordx4 v242, s[32:35], s62 offen offset:2048 lds
    buffer_load_dwordx4 v243, s[32:35], s62 offen offset:3072 lds
    v_mov_b32 v8, s48
    v_mov_b32 v9, s49
    s_mov_b32 exec_lo, 16843009
    s_mov_b32 exec_hi, 16843009
    v_mov_b32 v8, 0
    v_mov_b32 v9, 0
    buffer_atomic_or_x2 v[8:9], v232, s[40:43], 0 offen sc0 sc1
    s_mov_b64 exec, -1
    s_add_u32 m0, s0, 86016
    s_lshl_b32 s62, s13, 3
    buffer_load_dwordx4 v240, s[32:35], s62 offen offset:0 lds
    buffer_load_dwordx4 v241, s[32:35], s62 offen offset:1024 lds
    buffer_load_dwordx4 v242, s[32:35], s62 offen offset:2048 lds
    buffer_load_dwordx4 v243, s[32:35], s62 offen offset:3072 lds
    buffer_load_dwordx4 v[4:7], v248, s[4:7], 0 offen
    s_waitcnt vmcnt(5)
    s_mov_b32 s57, 400000
    s_branch recurrent_scan__ssm_conv_h3__glu_gated_bilinear__prompt_kernel_pc8
recurrent_scan__ssm_conv_h3__glu_gated_bilinear__prompt_kernel_pl7:
    v_mov_b32 v8, s48
    v_mov_b32 v9, s49
    s_mov_b32 exec_lo, 16843009
    s_mov_b32 exec_hi, 16843009
    v_mov_b32 v8, 0
    v_mov_b32 v9, 0
    buffer_atomic_or_x2 v[8:9], v232, s[40:43], 0 offen sc0 sc1
    s_mov_b64 exec, -1
    s_waitcnt vmcnt(0)
recurrent_scan__ssm_conv_h3__glu_gated_bilinear__prompt_kernel_pc8:
    v_cmp_ne_u32 vcc, s48, v8
    v_cmp_ne_u32 s[58:59], s49, v9
    s_nop 1
    s_or_b64 vcc, vcc, s[58:59]
    s_cbranch_scc0 recurrent_scan__ssm_conv_h3__glu_gated_bilinear__prompt_kernel_pd9
    s_sleep 4
    s_sub_u32 s57, s57, 1
    s_cbranch_scc0 recurrent_scan__ssm_conv_h3__glu_gated_bilinear__prompt_kernel_pl7
recurrent_scan__ssm_conv_h3__glu_gated_bilinear__prompt_kernel_pd9:
    buffer_load_dwordx4 v[144:147], v230, s[40:43], s8 offen offset:0 sc1
    buffer_load_dwordx4 v[148:151], v230, s[40:43], s8 offen offset:256 sc1
    buffer_load_dwordx4 v[152:155], v230, s[40:43], s8 offen offset:1024 sc1
    buffer_load_dwordx4 v[156:159], v230, s[40:43], s8 offen offset:1280 sc1
    buffer_load_dwordx4 v[160:163], v230, s[40:43], s9 offen offset:0 sc1
    buffer_load_dwordx4 v[164:167], v230, s[40:43], s9 offen offset:256 sc1
    buffer_load_dwordx4 v[168:171], v230, s[40:43], s9 offen offset:1024 sc1
    buffer_load_dwordx4 v[172:175], v230, s[40:43], s9 offen offset:1280 sc1
    s_setprio 0
    s_waitcnt vmcnt(7)
    v_mfma_f32_16x16x32_bf16 v[16:19], v[80:83], v[144:147], 0
    buffer_load_dwordx4 v[176:179], v230, s[40:43], s10 offen offset:0 sc1
    buffer_load_dwordx4 v[180:183], v230, s[40:43], s10 offen offset:256 sc1
    buffer_load_dwordx4 v[244:247], v249, s[40:43], 0 offen sc1
    v_mfma_f32_16x16x32_bf16 v[20:23], v[84:87], v[144:147], 0
    v_mfma_f32_16x16x32_bf16 v[24:27], v[88:91], v[144:147], 0
    v_mfma_f32_16x16x32_bf16 v[28:31], v[92:95], v[144:147], 0
    s_waitcnt vmcnt(9)
    v_mfma_f32_16x16x32_bf16 v[32:35], v[80:83], v[148:151], 0
    buffer_load_dwordx4 v[184:187], v230, s[40:43], s10 offen offset:1024 sc1
    buffer_load_dwordx4 v[188:191], v230, s[40:43], s10 offen offset:1280 sc1
    v_mfma_f32_16x16x32_bf16 v[36:39], v[84:87], v[148:151], 0
    v_mfma_f32_16x16x32_bf16 v[40:43], v[88:91], v[148:151], 0
    v_mfma_f32_16x16x32_bf16 v[44:47], v[92:95], v[148:151], 0
    s_waitcnt vmcnt(10)
    v_mfma_f32_16x16x32_bf16 v[48:51], v[80:83], v[152:155], 0
    buffer_load_dwordx4 v[144:147], v230, s[40:43], s11 offen offset:0 sc1
    buffer_load_dwordx4 v[148:151], v230, s[40:43], s11 offen offset:256 sc1
    v_mfma_f32_16x16x32_bf16 v[52:55], v[84:87], v[152:155], 0
    v_mfma_f32_16x16x32_bf16 v[56:59], v[88:91], v[152:155], 0
    v_mfma_f32_16x16x32_bf16 v[60:63], v[92:95], v[152:155], 0
    s_waitcnt vmcnt(11)
    v_mfma_f32_16x16x32_bf16 v[64:67], v[80:83], v[156:159], 0
    buffer_load_dwordx4 v[152:155], v230, s[40:43], s11 offen offset:1024 sc1
    v_mfma_f32_16x16x32_bf16 v[68:71], v[84:87], v[156:159], 0
    v_mfma_f32_16x16x32_bf16 v[72:75], v[88:91], v[156:159], 0
    v_mfma_f32_16x16x32_bf16 v[76:79], v[92:95], v[156:159], 0
    s_waitcnt vmcnt(11)
    v_mfma_f32_16x16x32_bf16 v[16:19], v[96:99], v[160:163], v[16:19]
    buffer_load_dwordx4 v[156:159], v230, s[40:43], s11 offen offset:1280 sc1
    v_mfma_f32_16x16x32_bf16 v[20:23], v[100:103], v[160:163], v[20:23]
    ds_read_b64_tr_b16 v[80:81], v253 offset:0
    v_mfma_f32_16x16x32_bf16 v[24:27], v[104:107], v[160:163], v[24:27]
    ds_read_b64_tr_b16 v[82:83], v253 offset:1024
    v_mfma_f32_16x16x32_bf16 v[28:31], v[108:111], v[160:163], v[28:31]
    ds_read_b64_tr_b16 v[84:85], v239 offset:0
    s_waitcnt vmcnt(11)
    v_mfma_f32_16x16x32_bf16 v[32:35], v[96:99], v[164:167], v[32:35]
    buffer_load_dwordx4 v[160:163], v230, s[40:43], s12 offen offset:0 sc1
    v_mfma_f32_16x16x32_bf16 v[36:39], v[100:103], v[164:167], v[36:39]
    ds_read_b64_tr_b16 v[86:87], v239 offset:1024
    v_mfma_f32_16x16x32_bf16 v[40:43], v[104:107], v[164:167], v[40:43]
    ds_read_b64_tr_b16 v[88:89], v253 offset:256
    v_mfma_f32_16x16x32_bf16 v[44:47], v[108:111], v[164:167], v[44:47]
    ds_read_b64_tr_b16 v[90:91], v253 offset:1280
    s_waitcnt vmcnt(11)
    v_mfma_f32_16x16x32_bf16 v[48:51], v[96:99], v[168:171], v[48:51]
    buffer_load_dwordx4 v[164:167], v230, s[40:43], s12 offen offset:256 sc1
    v_mfma_f32_16x16x32_bf16 v[52:55], v[100:103], v[168:171], v[52:55]
    ds_read_b64_tr_b16 v[92:93], v239 offset:256
    v_mfma_f32_16x16x32_bf16 v[56:59], v[104:107], v[168:171], v[56:59]
    ds_read_b64_tr_b16 v[94:95], v239 offset:1280
    v_mfma_f32_16x16x32_bf16 v[60:63], v[108:111], v[168:171], v[60:63]
    s_waitcnt vmcnt(11)
    v_mfma_f32_16x16x32_bf16 v[64:67], v[96:99], v[172:175], v[64:67]
    buffer_load_dwordx4 v[168:171], v230, s[40:43], s12 offen offset:1024 sc1
    v_mfma_f32_16x16x32_bf16 v[68:71], v[100:103], v[172:175], v[68:71]
    v_mfma_f32_16x16x32_bf16 v[72:75], v[104:107], v[172:175], v[72:75]
    v_mfma_f32_16x16x32_bf16 v[76:79], v[108:111], v[172:175], v[76:79]
    s_waitcnt lgkmcnt(0)
    s_waitcnt vmcnt(11)
    v_mfma_f32_16x16x32_bf16 v[16:19], v[112:115], v[176:179], v[16:19]
    buffer_load_dwordx4 v[172:175], v230, s[40:43], s12 offen offset:1280 sc1
    v_mfma_f32_16x16x32_bf16 v[20:23], v[116:119], v[176:179], v[20:23]
    ds_read_b64_tr_b16 v[96:97], v253 offset:4096
    v_mfma_f32_16x16x32_bf16 v[24:27], v[120:123], v[176:179], v[24:27]
    ds_read_b64_tr_b16 v[98:99], v253 offset:5120
    v_mfma_f32_16x16x32_bf16 v[28:31], v[124:127], v[176:179], v[28:31]
    ds_read_b64_tr_b16 v[100:101], v239 offset:4096
    s_waitcnt vmcnt(11)
    v_mfma_f32_16x16x32_bf16 v[32:35], v[112:115], v[180:183], v[32:35]
    buffer_load_dwordx4 v[176:179], v230, s[40:43], s13 offen offset:0 sc1
    v_mfma_f32_16x16x32_bf16 v[36:39], v[116:119], v[180:183], v[36:39]
    ds_read_b64_tr_b16 v[102:103], v239 offset:5120
    v_mfma_f32_16x16x32_bf16 v[40:43], v[120:123], v[180:183], v[40:43]
    ds_read_b64_tr_b16 v[104:105], v253 offset:4352
    v_mfma_f32_16x16x32_bf16 v[44:47], v[124:127], v[180:183], v[44:47]
    ds_read_b64_tr_b16 v[106:107], v253 offset:5376
    s_waitcnt vmcnt(10)
    v_mfma_f32_16x16x32_bf16 v[48:51], v[112:115], v[184:187], v[48:51]
    buffer_load_dwordx4 v[180:183], v230, s[40:43], s13 offen offset:256 sc1
    v_mfma_f32_16x16x32_bf16 v[52:55], v[116:119], v[184:187], v[52:55]
    ds_read_b64_tr_b16 v[108:109], v239 offset:4352
    v_mfma_f32_16x16x32_bf16 v[56:59], v[120:123], v[184:187], v[56:59]
    ds_read_b64_tr_b16 v[110:111], v239 offset:5376
    v_mfma_f32_16x16x32_bf16 v[60:63], v[124:127], v[184:187], v[60:63]
    s_waitcnt vmcnt(10)
    v_mfma_f32_16x16x32_bf16 v[64:67], v[112:115], v[188:191], v[64:67]
    buffer_load_dwordx4 v[184:187], v230, s[40:43], s13 offen offset:1024 sc1
    v_mfma_f32_16x16x32_bf16 v[68:71], v[116:119], v[188:191], v[68:71]
    v_mfma_f32_16x16x32_bf16 v[72:75], v[120:123], v[188:191], v[72:75]
    v_mfma_f32_16x16x32_bf16 v[76:79], v[124:127], v[188:191], v[76:79]
    s_waitcnt lgkmcnt(0)
    s_waitcnt vmcnt(10)
    v_mfma_f32_16x16x32_bf16 v[16:19], v[128:131], v[144:147], v[16:19]
    buffer_load_dwordx4 v[188:191], v230, s[40:43], s13 offen offset:1280 sc1
    v_mfma_f32_16x16x32_bf16 v[20:23], v[132:135], v[144:147], v[20:23]
    ds_read_b64_tr_b16 v[112:113], v252 offset:0
    v_mfma_f32_16x16x32_bf16 v[24:27], v[136:139], v[144:147], v[24:27]
    ds_read_b64_tr_b16 v[114:115], v252 offset:1024
    v_mfma_f32_16x16x32_bf16 v[28:31], v[140:143], v[144:147], v[28:31]
    ds_read_b64_tr_b16 v[116:117], v238 offset:0
    s_waitcnt vmcnt(10)
    v_mfma_f32_16x16x32_bf16 v[32:35], v[128:131], v[148:151], v[32:35]
    buffer_load_dwordx4 v[144:147], v230, s[40:43], s14 offen offset:0 sc1
    v_mfma_f32_16x16x32_bf16 v[36:39], v[132:135], v[148:151], v[36:39]
    ds_read_b64_tr_b16 v[118:119], v238 offset:1024
    v_mfma_f32_16x16x32_bf16 v[40:43], v[136:139], v[148:151], v[40:43]
    ds_read_b64_tr_b16 v[120:121], v252 offset:256
    v_mfma_f32_16x16x32_bf16 v[44:47], v[140:143], v[148:151], v[44:47]
    ds_read_b64_tr_b16 v[122:123], v252 offset:1280
    s_waitcnt vmcnt(10)
    v_mfma_f32_16x16x32_bf16 v[48:51], v[128:131], v[152:155], v[48:51]
    buffer_load_dwordx4 v[148:151], v230, s[40:43], s14 offen offset:256 sc1
    v_mfma_f32_16x16x32_bf16 v[52:55], v[132:135], v[152:155], v[52:55]
    ds_read_b64_tr_b16 v[124:125], v238 offset:256
    v_mfma_f32_16x16x32_bf16 v[56:59], v[136:139], v[152:155], v[56:59]
    ds_read_b64_tr_b16 v[126:127], v238 offset:1280
    v_mfma_f32_16x16x32_bf16 v[60:63], v[140:143], v[152:155], v[60:63]
    s_mov_b32 s74, 0xffff0000
    s_waitcnt vmcnt(10)
    v_mfma_f32_16x16x32_bf16 v[64:67], v[128:131], v[156:159], v[64:67]
    buffer_load_dwordx4 v[152:155], v230, s[40:43], s14 offen offset:1024 sc1
    v_mfma_f32_16x16x32_bf16 v[68:71], v[132:135], v[156:159], v[68:71]
    v_lshlrev_b32 v208, 16, v4
    v_mfma_f32_16x16x32_bf16 v[72:75], v[136:139], v[156:159], v[72:75]
    v_and_b32 v209, s74, v4
    v_mfma_f32_16x16x32_bf16 v[76:79], v[140:143], v[156:159], v[76:79]
    v_lshlrev_b32 v210, 16, v5
    s_waitcnt lgkmcnt(0)
    s_waitcnt vmcnt(10)
    v_mfma_f32_16x16x32_bf16 v[16:19], v[80:83], v[160:163], v[16:19]
    buffer_load_dwordx4 v[156:159], v230, s[40:43], s14 offen offset:1280 sc1
    v_mfma_f32_16x16x32_bf16 v[20:23], v[84:87], v[160:163], v[20:23]
    ds_read_b64_tr_b16 v[128:129], v252 offset:4096
    v_mfma_f32_16x16x32_bf16 v[24:27], v[88:91], v[160:163], v[24:27]
    ds_read_b64_tr_b16 v[130:131], v252 offset:5120
    v_mfma_f32_16x16x32_bf16 v[28:31], v[92:95], v[160:163], v[28:31]
    ds_read_b64_tr_b16 v[132:133], v238 offset:4096
    s_waitcnt vmcnt(10)
    v_mfma_f32_16x16x32_bf16 v[32:35], v[80:83], v[164:167], v[32:35]
    buffer_load_dwordx4 v[160:163], v230, s[40:43], s15 offen offset:0 sc1
    v_mfma_f32_16x16x32_bf16 v[36:39], v[84:87], v[164:167], v[36:39]
    ds_read_b64_tr_b16 v[134:135], v238 offset:5120
    v_mfma_f32_16x16x32_bf16 v[40:43], v[88:91], v[164:167], v[40:43]
    ds_read_b64_tr_b16 v[136:137], v252 offset:4352
    v_mfma_f32_16x16x32_bf16 v[44:47], v[92:95], v[164:167], v[44:47]
    ds_read_b64_tr_b16 v[138:139], v252 offset:5376
    s_waitcnt vmcnt(10)
    v_mfma_f32_16x16x32_bf16 v[48:51], v[80:83], v[168:171], v[48:51]
    buffer_load_dwordx4 v[164:167], v230, s[40:43], s15 offen offset:256 sc1
    v_mfma_f32_16x16x32_bf16 v[52:55], v[84:87], v[168:171], v[52:55]
    ds_read_b64_tr_b16 v[140:141], v238 offset:4352
    v_mfma_f32_16x16x32_bf16 v[56:59], v[88:91], v[168:171], v[56:59]
    ds_read_b64_tr_b16 v[142:143], v238 offset:5376
    v_mfma_f32_16x16x32_bf16 v[60:63], v[92:95], v[168:171], v[60:63]
    v_and_b32 v211, s74, v5
    s_waitcnt vmcnt(10)
    v_mfma_f32_16x16x32_bf16 v[64:67], v[80:83], v[172:175], v[64:67]
    buffer_load_dwordx4 v[168:171], v230, s[40:43], s15 offen offset:1024 sc1
    v_mfma_f32_16x16x32_bf16 v[68:71], v[84:87], v[172:175], v[68:71]
    v_lshlrev_b32 v212, 16, v6
    v_mfma_f32_16x16x32_bf16 v[72:75], v[88:91], v[172:175], v[72:75]
    v_and_b32 v213, s74, v6
    v_mfma_f32_16x16x32_bf16 v[76:79], v[92:95], v[172:175], v[76:79]
    v_lshlrev_b32 v214, 16, v7
    s_waitcnt lgkmcnt(0)
    s_waitcnt vmcnt(10)
    v_mfma_f32_16x16x32_bf16 v[16:19], v[96:99], v[176:179], v[16:19]
    buffer_load_dwordx4 v[172:175], v230, s[40:43], s15 offen offset:1280 sc1
    v_mfma_f32_16x16x32_bf16 v[20:23], v[100:103], v[176:179], v[20:23]
    ds_read_b64_tr_b16 v[80:81], v252 offset:40960
    v_mfma_f32_16x16x32_bf16 v[24:27], v[104:107], v[176:179], v[24:27]
    ds_read_b64_tr_b16 v[82:83], v252 offset:41984
    v_mfma_f32_16x16x32_bf16 v[28:31], v[108:111], v[176:179], v[28:31]
    ds_read_b64_tr_b16 v[84:85], v238 offset:40960
    s_waitcnt vmcnt(10)
    v_mfma_f32_16x16x32_bf16 v[32:35], v[96:99], v[180:183], v[32:35]
    buffer_load_dwordx4 v[176:179], v230, s[40:43], s16 offen offset:0 sc1
    v_mfma_f32_16x16x32_bf16 v[36:39], v[100:103], v[180:183], v[36:39]
    ds_read_b64_tr_b16 v[86:87], v238 offset:41984
    v_mfma_f32_16x16x32_bf16 v[40:43], v[104:107], v[180:183], v[40:43]
    ds_read_b64_tr_b16 v[88:89], v252 offset:41216
    v_mfma_f32_16x16x32_bf16 v[44:47], v[108:111], v[180:183], v[44:47]
    ds_read_b64_tr_b16 v[90:91], v252 offset:42240
    s_waitcnt vmcnt(10)
    v_mfma_f32_16x16x32_bf16 v[48:51], v[96:99], v[184:187], v[48:51]
    buffer_load_dwordx4 v[180:183], v230, s[40:43], s17 offen offset:0 sc1
    v_mfma_f32_16x16x32_bf16 v[52:55], v[100:103], v[184:187], v[52:55]
    ds_read_b64_tr_b16 v[92:93], v238 offset:41216
    v_mfma_f32_16x16x32_bf16 v[56:59], v[104:107], v[184:187], v[56:59]
    ds_read_b64_tr_b16 v[94:95], v238 offset:42240
    v_mfma_f32_16x16x32_bf16 v[60:63], v[108:111], v[184:187], v[60:63]
    v_and_b32 v215, s74, v7
    s_waitcnt vmcnt(10)
    v_mfma_f32_16x16x32_bf16 v[64:67], v[96:99], v[188:191], v[64:67]
    buffer_load_dwordx4 v[184:187], v230, s[40:43], s18 offen offset:0 sc1
    v_mfma_f32_16x16x32_bf16 v[68:71], v[100:103], v[188:191], v[68:71]
    v_mul_f32 v246, v245, v245
    v_mfma_f32_16x16x32_bf16 v[72:75], v[104:107], v[188:191], v[72:75]
    v_mul_f32 v247, v246, v245
    v_mfma_f32_16x16x32_bf16 v[76:79], v[108:111], v[188:191], v[76:79]
    v_mul_f32 v246, 0xbfb8aa3b, v246
    s_waitcnt lgkmcnt(0)
    s_waitcnt vmcnt(10)
    v_mfma_f32_16x16x32_bf16 v[16:19], v[112:115], v[144:147], v[16:19]
    buffer_load_dwordx4 v[188:191], v230, s[40:43], s16 offen offset:256 sc1
    v_mfma_f32_16x16x32_bf16 v[20:23], v[116:119], v[144:147], v[20:23]
    ds_read_b64_tr_b16 v[96:97], v252 offset:45056
    v_mfma_f32_16x16x32_bf16 v[24:27], v[120:123], v[144:147], v[24:27]
    ds_read_b64_tr_b16 v[98:99], v252 offset:46080
    v_mfma_f32_16x16x32_bf16 v[28:31], v[124:127], v[144:147], v[28:31]
    ds_read_b64_tr_b16 v[100:101], v238 offset:45056
    s_waitcnt vmcnt(10)
    v_mfma_f32_16x16x32_bf16 v[32:35], v[112:115], v[148:151], v[32:35]
    buffer_load_dwordx4 v[144:147], v230, s[40:43], s17 offen offset:256 sc1
    v_mfma_f32_16x16x32_bf16 v[36:39], v[116:119], v[148:151], v[36:39]
    ds_read_b64_tr_b16 v[102:103], v238 offset:46080
    v_mfma_f32_16x16x32_bf16 v[40:43], v[120:123], v[148:151], v[40:43]
    ds_read_b64_tr_b16 v[104:105], v252 offset:45312
    v_mfma_f32_16x16x32_bf16 v[44:47], v[124:127], v[148:151], v[44:47]
    ds_read_b64_tr_b16 v[106:107], v252 offset:46336
    s_waitcnt vmcnt(10)
    v_mfma_f32_16x16x32_bf16 v[48:51], v[112:115], v[152:155], v[48:51]
    buffer_load_dwordx4 v[148:151], v230, s[40:43], s18 offen offset:256 sc1
    v_mfma_f32_16x16x32_bf16 v[52:55], v[116:119], v[152:155], v[52:55]
    ds_read_b64_tr_b16 v[108:109], v238 offset:45312
    v_mfma_f32_16x16x32_bf16 v[56:59], v[120:123], v[152:155], v[56:59]
    ds_read_b64_tr_b16 v[110:111], v238 offset:46336
    v_mfma_f32_16x16x32_bf16 v[60:63], v[124:127], v[152:155], v[60:63]
    v_sub_f32 v216, v208, v244
    s_waitcnt vmcnt(10)
    v_mfma_f32_16x16x32_bf16 v[64:67], v[112:115], v[156:159], v[64:67]
    buffer_load_dwordx4 v[152:155], v230, s[40:43], s16 offen offset:1024 sc1
    v_mfma_f32_16x16x32_bf16 v[68:71], v[116:119], v[156:159], v[68:71]
    v_sub_f32 v217, v209, v244
    v_mfma_f32_16x16x32_bf16 v[72:75], v[120:123], v[156:159], v[72:75]
    v_sub_f32 v218, v210, v244
    v_mfma_f32_16x16x32_bf16 v[76:79], v[124:127], v[156:159], v[76:79]
    v_sub_f32 v219, v211, v244
    s_waitcnt lgkmcnt(0)
    s_waitcnt vmcnt(10)
    v_mfma_f32_16x16x32_bf16 v[16:19], v[128:131], v[160:163], v[16:19]
    buffer_load_dwordx4 v[156:159], v230, s[40:43], s17 offen offset:1024 sc1
    v_mfma_f32_16x16x32_bf16 v[20:23], v[132:135], v[160:163], v[20:23]
    ds_read_b64_tr_b16 v[112:113], v254 offset:0
    v_mfma_f32_16x16x32_bf16 v[24:27], v[136:139], v[160:163], v[24:27]
    ds_read_b64_tr_b16 v[114:115], v254 offset:1024
    v_mfma_f32_16x16x32_bf16 v[28:31], v[140:143], v[160:163], v[28:31]
    ds_read_b64_tr_b16 v[116:117], v255 offset:0
    s_waitcnt vmcnt(10)
    v_mfma_f32_16x16x32_bf16 v[32:35], v[128:131], v[164:167], v[32:35]
    buffer_load_dwordx4 v[160:163], v230, s[40:43], s18 offen offset:1024 sc1
    v_mfma_f32_16x16x32_bf16 v[36:39], v[132:135], v[164:167], v[36:39]
    ds_read_b64_tr_b16 v[118:119], v255 offset:1024
    v_mfma_f32_16x16x32_bf16 v[40:43], v[136:139], v[164:167], v[40:43]
    ds_read_b64_tr_b16 v[120:121], v254 offset:256
    v_mfma_f32_16x16x32_bf16 v[44:47], v[140:143], v[164:167], v[44:47]
    ds_read_b64_tr_b16 v[122:123], v254 offset:1280
    ds_write_b32 v250, v251 offset:4176
    s_waitcnt vmcnt(10)
    v_mfma_f32_16x16x32_bf16 v[48:51], v[128:131], v[168:171], v[48:51]
    buffer_load_dwordx4 v[164:167], v230, s[40:43], s16 offen offset:1280 sc1
    v_mfma_f32_16x16x32_bf16 v[52:55], v[132:135], v[168:171], v[52:55]
    ds_read_b64_tr_b16 v[124:125], v255 offset:256
    v_mfma_f32_16x16x32_bf16 v[56:59], v[136:139], v[168:171], v[56:59]
    ds_read_b64_tr_b16 v[126:127], v255 offset:1280
    v_mfma_f32_16x16x32_bf16 v[60:63], v[140:143], v[168:171], v[60:63]
    v_sub_f32 v220, v212, v244
    s_waitcnt vmcnt(10)
    v_mfma_f32_16x16x32_bf16 v[64:67], v[128:131], v[172:175], v[64:67]
    buffer_load_dwordx4 v[168:171], v230, s[40:43], s17 offen offset:1280 sc1
    v_mfma_f32_16x16x32_bf16 v[68:71], v[132:135], v[172:175], v[68:71]
    v_sub_f32 v221, v213, v244
    v_mfma_f32_16x16x32_bf16 v[72:75], v[136:139], v[172:175], v[72:75]
    v_sub_f32 v222, v214, v244
    v_mfma_f32_16x16x32_bf16 v[76:79], v[140:143], v[172:175], v[76:79]
    v_sub_f32 v223, v215, v244
    s_waitcnt lgkmcnt(0)
    s_waitcnt vmcnt(10)
    v_mfma_f32_16x16x32_bf16 v[16:19], v[80:83], v[176:179], v[16:19]
    buffer_load_dwordx4 v[172:175], v230, s[40:43], s18 offen offset:1280 sc1
    v_mfma_f32_16x16x32_bf16 v[20:23], v[84:87], v[176:179], v[20:23]
    v_mul_f32 v216, v216, v247
    v_mfma_f32_16x16x32_bf16 v[24:27], v[88:91], v[176:179], v[24:27]
    v_mul_f32 v217, v217, v247
    v_mfma_f32_16x16x32_bf16 v[28:31], v[92:95], v[176:179], v[28:31]
    v_mul_f32 v218, v218, v247
    s_waitcnt vmcnt(10)
    v_mfma_f32_16x16x32_bf16 v[16:19], v[96:99], v[180:183], v[16:19]
    v_mul_f32 v219, v219, v247
    v_mfma_f32_16x16x32_bf16 v[20:23], v[100:103], v[180:183], v[20:23]
    v_mul_f32 v220, v220, v247
    v_mfma_f32_16x16x32_bf16 v[24:27], v[104:107], v[180:183], v[24:27]
    v_mul_f32 v221, v221, v247
    v_mfma_f32_16x16x32_bf16 v[28:31], v[108:111], v[180:183], v[28:31]
    v_mul_f32 v222, v222, v247
    s_waitcnt vmcnt(9)
    v_mfma_f32_16x16x32_bf16 v[16:19], v[112:115], v[184:187], v[16:19]
    v_mul_f32 v223, v223, v247
    v_mfma_f32_16x16x32_bf16 v[20:23], v[116:119], v[184:187], v[20:23]
    v_mfma_f32_16x16x32_bf16 v[24:27], v[120:123], v[184:187], v[24:27]
    v_mfma_f32_16x16x32_bf16 v[28:31], v[124:127], v[184:187], v[28:31]
    s_waitcnt vmcnt(8)
    v_mfma_f32_16x16x32_bf16 v[32:35], v[80:83], v[188:191], v[32:35]
    v_mfma_f32_16x16x32_bf16 v[36:39], v[84:87], v[188:191], v[36:39]
    v_mfma_f32_16x16x32_bf16 v[40:43], v[88:91], v[188:191], v[40:43]
    v_mfma_f32_16x16x32_bf16 v[44:47], v[92:95], v[188:191], v[44:47]
    s_waitcnt vmcnt(7)
    v_mfma_f32_16x16x32_bf16 v[32:35], v[96:99], v[144:147], v[32:35]
    ds_write_b128 v234, v[16:19] offset:0
    v_mfma_f32_16x16x32_bf16 v[36:39], v[100:103], v[144:147], v[36:39]
    v_mfma_f32_16x16x32_bf16 v[40:43], v[104:107], v[144:147], v[40:43]
    ds_write_b128 v235, v[20:23] offset:0
    v_mfma_f32_16x16x32_bf16 v[44:47], v[108:111], v[144:147], v[44:47]
    s_waitcnt vmcnt(6)
    v_mfma_f32_16x16x32_bf16 v[32:35], v[112:115], v[148:151], v[32:35]
    ds_write_b128 v234, v[24:27] offset:128
    v_mfma_f32_16x16x32_bf16 v[36:39], v[116:119], v[148:151], v[36:39]
    v_mfma_f32_16x16x32_bf16 v[40:43], v[120:123], v[148:151], v[40:43]
    ds_write_b128 v235, v[28:31] offset:128
    v_mfma_f32_16x16x32_bf16 v[44:47], v[124:127], v[148:151], v[44:47]
    s_waitcnt vmcnt(5)
    v_mfma_f32_16x16x32_bf16 v[48:51], v[80:83], v[152:155], v[48:51]
    v_mfma_f32_16x16x32_bf16 v[52:55], v[84:87], v[152:155], v[52:55]
    v_mfma_f32_16x16x32_bf16 v[56:59], v[88:91], v[152:155], v[56:59]
    v_mfma_f32_16x16x32_bf16 v[60:63], v[92:95], v[152:155], v[60:63]
    s_waitcnt vmcnt(4)
    v_mfma_f32_16x16x32_bf16 v[48:51], v[96:99], v[156:159], v[48:51]
    ds_write_b128 v234, v[32:35] offset:4096
    v_mfma_f32_16x16x32_bf16 v[52:55], v[100:103], v[156:159], v[52:55]
    v_mfma_f32_16x16x32_bf16 v[56:59], v[104:107], v[156:159], v[56:59]
    ds_write_b128 v235, v[36:39] offset:4096
    v_mfma_f32_16x16x32_bf16 v[60:63], v[108:111], v[156:159], v[60:63]
    s_waitcnt vmcnt(3)
    v_mfma_f32_16x16x32_bf16 v[48:51], v[112:115], v[160:163], v[48:51]
    ds_write_b128 v234, v[40:43] offset:4224
    v_mfma_f32_16x16x32_bf16 v[52:55], v[116:119], v[160:163], v[52:55]
    v_mfma_f32_16x16x32_bf16 v[56:59], v[120:123], v[160:163], v[56:59]
    ds_write_b128 v235, v[44:47] offset:4224
    v_mfma_f32_16x16x32_bf16 v[60:63], v[124:127], v[160:163], v[60:63]
    s_waitcnt vmcnt(2)
    v_mfma_f32_16x16x32_bf16 v[64:67], v[80:83], v[164:167], v[64:67]
    v_mfma_f32_16x16x32_bf16 v[68:71], v[84:87], v[164:167], v[68:71]
    v_mfma_f32_16x16x32_bf16 v[72:75], v[88:91], v[164:167], v[72:75]
    v_mfma_f32_16x16x32_bf16 v[76:79], v[92:95], v[164:167], v[76:79]
    s_waitcnt vmcnt(1)
    v_mfma_f32_16x16x32_bf16 v[64:67], v[96:99], v[168:171], v[64:67]
    ds_write_b128 v234, v[48:51] offset:40960
    v_mfma_f32_16x16x32_bf16 v[68:71], v[100:103], v[168:171], v[68:71]
    v_mfma_f32_16x16x32_bf16 v[72:75], v[104:107], v[168:171], v[72:75]
    ds_write_b128 v235, v[52:55] offset:40960
    v_mfma_f32_16x16x32_bf16 v[76:79], v[108:111], v[168:171], v[76:79]
    s_waitcnt vmcnt(0)
    v_mfma_f32_16x16x32_bf16 v[64:67], v[112:115], v[172:175], v[64:67]
    ds_write_b128 v234, v[56:59] offset:41088
    v_mfma_f32_16x16x32_bf16 v[68:71], v[116:119], v[172:175], v[68:71]
    v_mfma_f32_16x16x32_bf16 v[72:75], v[120:123], v[172:175], v[72:75]
    ds_write_b128 v235, v[60:63] offset:41088
    v_mfma_f32_16x16x32_bf16 v[76:79], v[124:127], v[172:175], v[76:79]
    s_nop 2
    ds_write_b128 v234, v[64:67] offset:45056
    s_nop 0
    ds_write_b128 v235, v[68:71] offset:45056
    ds_write_b128 v234, v[72:75] offset:45184
    s_nop 0
    ds_write_b128 v235, v[76:79] offset:45184
recurrent_scan__ssm_conv_h3__glu_gated_bilinear__prompt_kernel_final:
    s_waitcnt lgkmcnt(0)
    s_barrier
    ds_read_b128 v[112:115], v224 offset:0
    ds_read_b128 v[116:119], v225 offset:0
    ds_read_b128 v[120:123], v224 offset:8192
    ds_read_b128 v[124:127], v225 offset:8192
    ds_read_b128 v[128:131], v224 offset:16384
    ds_read_b128 v[132:135], v225 offset:16384
    ds_read_b128 v[136:139], v224 offset:24576
    ds_read_b128 v[140:143], v225 offset:24576
    ds_read_b128 v[144:147], v226
    s_waitcnt lgkmcnt(5)
    v_pk_add_f32 v[112:113], v[112:113], v[120:121]
    v_pk_add_f32 v[114:115], v[114:115], v[122:123]
    v_pk_add_f32 v[116:117], v[116:117], v[124:125]
    v_pk_add_f32 v[118:119], v[118:119], v[126:127]
    s_waitcnt lgkmcnt(1)
    v_pk_add_f32 v[128:129], v[128:129], v[136:137]
    v_pk_add_f32 v[130:131], v[130:131], v[138:139]
    v_pk_add_f32 v[132:133], v[132:133], v[140:141]
    v_pk_add_f32 v[134:135], v[134:135], v[142:143]
    v_pk_add_f32 v[112:113], v[112:113], v[128:129]
    v_pk_add_f32 v[114:115], v[114:115], v[130:131]
    v_pk_add_f32 v[116:117], v[116:117], v[132:133]
    v_pk_add_f32 v[118:119], v[118:119], v[134:135]
    v_pk_mul_f32 v[120:121], v[112:113], v[246:247] op_sel_hi:[1,0]
    v_pk_mul_f32 v[122:123], v[114:115], v[246:247] op_sel_hi:[1,0]
    v_pk_mul_f32 v[124:125], v[116:117], v[246:247] op_sel_hi:[1,0]
    v_pk_mul_f32 v[126:127], v[118:119], v[246:247] op_sel_hi:[1,0]
    v_exp_f32 v120, v120
    v_exp_f32 v121, v121
    v_exp_f32 v122, v122
    v_exp_f32 v123, v123
    v_exp_f32 v124, v124
    v_exp_f32 v125, v125
    v_exp_f32 v126, v126
    v_exp_f32 v127, v127
    s_waitcnt lgkmcnt(0)
    v_lshlrev_b32 v128, 16, v144
    v_and_b32 v129, s74, v144
    v_lshlrev_b32 v130, 16, v145
    v_and_b32 v131, s74, v145
    v_lshlrev_b32 v132, 16, v146
    v_and_b32 v133, s74, v146
    v_lshlrev_b32 v134, 16, v147
    v_and_b32 v135, s74, v147
    v_pk_add_f32 v[120:121], v[120:121], v[228:229] op_sel_hi:[1,0]
    v_pk_add_f32 v[122:123], v[122:123], v[228:229] op_sel_hi:[1,0]
    v_pk_add_f32 v[124:125], v[124:125], v[228:229] op_sel_hi:[1,0]
    v_pk_add_f32 v[126:127], v[126:127], v[228:229] op_sel_hi:[1,0]
    v_rcp_f32 v120, v120
    v_rcp_f32 v121, v121
    v_rcp_f32 v122, v122
    v_rcp_f32 v123, v123
    v_rcp_f32 v124, v124
    v_rcp_f32 v125, v125
    v_rcp_f32 v126, v126
    v_rcp_f32 v127, v127
    v_pk_mul_f32 v[216:217], v[216:217], v[128:129]
    v_pk_mul_f32 v[218:219], v[218:219], v[130:131]
    v_pk_mul_f32 v[220:221], v[220:221], v[132:133]
    v_pk_mul_f32 v[222:223], v[222:223], v[134:135]
    v_pk_mul_f32 v[112:113], v[112:113], v[120:121]
    v_pk_mul_f32 v[114:115], v[114:115], v[122:123]
    v_pk_mul_f32 v[116:117], v[116:117], v[124:125]
    v_pk_mul_f32 v[118:119], v[118:119], v[126:127]
    v_pk_fma_f32 v[208:209], v[216:217], v[112:113], v[208:209]
    v_pk_fma_f32 v[210:211], v[218:219], v[114:115], v[210:211]
    v_pk_fma_f32 v[212:213], v[220:221], v[116:117], v[212:213]
    v_pk_fma_f32 v[214:215], v[222:223], v[118:119], v[214:215]
    v_cvt_pk_bf16_f32 v148, v208, v209
    v_cvt_pk_bf16_f32 v149, v210, v211
    v_cvt_pk_bf16_f32 v150, v212, v213
    v_cvt_pk_bf16_f32 v151, v214, v215
    buffer_store_dwordx4 v[148:151], v248, s[36:39], 0 offen sc1
recurrent_scan__ssm_conv_h3__glu_gated_bilinear__prompt_kernel_fin2:
    s_endpgm
recurrent_scan__ssm_conv_h3__glu_gated_bilinear__prompt_kernel_Cw:
    s_add_u32 m0, s24, 131584
    s_nop 0
    buffer_load_dwordx4 v236, s[8:11], 0 offen offset:0 lds
    buffer_load_dwordx4 v239, s[8:11], 0 offen offset:1024 lds
    s_add_u32 m0, s24, 139776
    s_nop 0
    buffer_load_dwordx4 v236, s[12:15], 0 offen offset:0 lds
    buffer_load_dwordx4 v239, s[12:15], 0 offen offset:1024 lds
    s_cmp_lg_u32 s47, 0
    s_cbranch_scc1 recurrent_scan__ssm_conv_h3__glu_gated_bilinear__prompt_kernel_kh10
    s_mov_b32 m0, 130560
    s_nop 0
    buffer_load_dwordx4 v237, s[8:11], 0 offen lds
recurrent_scan__ssm_conv_h3__glu_gated_bilinear__prompt_kernel_kh10:
    buffer_load_dwordx4 v[220:223], v238, s[16:19], 0 offen
    s_mov_b32 s38, 2097152
    s_mov_b32 s39, s3
    s_mov_b64 s[36:37], s[96:97]
    v_and_b32 v7, 7, v0
    v_lshrrev_b32 v8, 2, v7
    v_lshrrev_b32 v9, 5, v0
    v_xor_b32 v8, v8, v9
    v_lshlrev_b32 v8, 4, v8
    v_lshl_add_u32 v8, v7, 5, v8
    v_and_b32 v9, 3, v4
    v_lshl_add_u32 v8, v9, 2, v8
    v_add_u32 v246, s24, v8
    v_lshrrev_b32 v8, 5, v0
    v_lshl_add_u32 v8, s47, 1, v8
    v_lshlrev_b32 v9, 2, v9
    v_lshl_add_u32 v9, v7, 10, v9
    v_add_u32 v9, 130560, v9
    v_xor_b32 v246, v8, v7
    v_lshl_add_u32 v246, v246, 4, v9
    v_add_u32 v245, 7, v7
    v_and_b32 v245, 7, v245
    v_xor_b32 v245, v8, v245
    v_lshl_add_u32 v245, v245, 4, v9
    v_lshlrev_b32 v5, 12, v5
    v_lshl_add_u32 v247, v7, 4, v5
    s_lshl_b32 s62, s55, 7
    s_add_u32 s0, s62, 1048576
    s_add_u32 s1, s0, 4096
    s_lshl_b32 s68, s68, 12
    s_add_u32 s68, s68, s62
    s_add_u32 s68, s68, 262144
    s_and_b32 s62, s46, 3
    s_and_b32 s63, s45, 6
    s_lshl1_add_u32 s51, s63, s62
    s_and_b32 s64, s45, 1
    s_mul_i32 s65, s64, 7
    s_lshr_b32 s66, s46, 2
    s_add_u32 s52, s65, s66
    s_lshr_b32 s62, s62, 1
    s_xor_b32 s62, s62, s64
    s_cmp_lt_u32 s66, 7
    s_cselect_b32 s52, s52, 14
    s_cselect_b32 s53, 0, s62
    s_lshl_b32 s62, s47, 2
    s_add_u32 s62, s62, 151328
    v_mov_b32 v255, s62
    v_mov_b32 v12, 0
    ds_write_b32 v255, v12 offset:0
    ds_write_b32 v255, v12 offset:4160
    ds_write_b32 v255, v12 offset:4176
    ds_write_b32 v255, v12 offset:8320
    ds_write_b32 v255, v12 offset:8336
    s_waitcnt lgkmcnt(0)
    s_add_u32 s48, s48, 1
    s_mul_i32 s49, s48, 0x9E3779B1
    s_add_u32 s49, s49, 0x7F4A7C15
    s_lshr_b32 s62, s47, 1
    s_and_b32 s63, s47, 1
    s_mul_i32 s64, s62, 16640
    s_lshl_b32 s65, s63, 8
    s_add_u32 s64, s64, s65
    s_add_u32 s64, s64, 130610
    s_mul_i32 s66, s62, 4608
    s_sub_u32 s66, s66, s65
    s_add_u32 s66, s66, 121632
    v_and_b32 v12, 15, v0
    v_lshrrev_b32 v13, 4, v0
    v_add_u32 v14, 1, v12
    v_and_b32 v14, 3, v14
    v_mul_u32_u24 v14, 4158, v14
    v_lshl_add_u32 v14, v12, 1, v14
    v_lshlrev_b32 v15, 4, v13
    v_sub_u32 v14, v14, v15
    v_add_u32 v10, s64, v14
    v_lshl_add_u32 v11, v12, 5, v15
    v_add_u32 v11, s66, v11
    s_lshl_b32 s62, s62, 4
    s_lshr_b32 s62, s50, s62
    s_and_b32 s62, s62, 0xffff
    s_cmp_eq_u32 s63, 1
    s_cselect_b32 s62, 0, s62
    v_and_b32 v12, 1, v0
    v_xor_b32 v12, 1, v12
    v_lshlrev_b32 v12, 4, v12
    v_lshlrev_b32 v12, v12, s62
    v_bfe_u32 v14, v0, 3, 1
    v_add_u32 v14, 2, v14
    v_cmp_eq_u32 vcc, v13, v14
    v_bfe_u32 v13, v0, 1, 2
    s_nop 0
    v_cndmask_b32 v12, 0, v12, vcc
    v_cmp_eq_u32 vcc, 3, v13
    s_nop 1
    v_cndmask_b32 v232, 0, v12, vcc
    v_cmp_eq_u32 vcc, 2, v13
    s_nop 1
    v_cndmask_b32 v233, 0, v12, vcc
    v_cmp_eq_u32 vcc, 1, v13
    s_nop 1
    v_cndmask_b32 v234, 0, v12, vcc
    v_cmp_eq_u32 vcc, 0, v13
    s_nop 1
    v_cndmask_b32 v235, 0, v12, vcc
    s_and_b32 s62, s47, 1
    s_lshr_b32 s63, s47, 1
    v_and_b32 v12, 15, v0
    v_bfe_u32 v13, v0, 1, 3
    v_lshrrev_b32 v14, 4, v0
    v_xor_b32 v13, v13, v14
    v_lshlrev_b32 v13, 4, v13
    v_lshl_add_u32 v13, v12, 7, v13
    s_lshl_b32 s64, s62, 13
    v_add_u32 v1, s64, v13
    v_xor_b32 v2, 64, v1
    v_lshrrev_b32 v15, 5, v0
    v_and_b32 v16, 1, v14
    v_mul_u32_u24 v5, 3072, v15
    v_mul_u32_u24 v13, 544, v16
    v_add_u32 v5, v5, v13
    v_bfe_u32 v13, v0, 2, 2
    v_lshl_add_u32 v5, v13, 6, v5
    v_and_b32 v13, 3, v0
    v_lshl_add_u32 v5, v13, 3, v5
    s_lshl_b32 s64, s63, 5
    v_xor_b32 v5, s64, v5
    v_xor_b32 v6, 32, v5
    s_lshl_b32 s64, s63, 10
    s_add_u32 s65, s64, 16384
    v_add_u32 v5, s65, v5
    s_add_u32 s65, s65, s64
    v_add_u32 v6, s65, v6
    s_lshl1_add_u32 s64, s51, s62
    s_lshl_b32 s65, s64, 10
    s_add_u32 s65, s65, 65536
    v_lshlrev_b32 v12, 4, v12
    v_add_u32 v7, s65, v12
    s_lshl_b32 s65, s62, 10
    s_add_u32 s65, s65, 122880
    v_add_u32 v249, s65, v12
    s_lshl1_add_u32 s65, s52, s63
    s_mul_i32 s67, s65, 3
    v_lshlrev_b32 v8, 4, v0
    v_lshl_add_u32 v3, v14, 9, v12
    v_lshl_add_u32 v13, v16, 9, v12
    v_lshl_add_u32 v13, v15, 8, v13
    s_mul_i32 s66, s64, 86
    s_add_u32 s66, s66, s67
    s_lshl_b32 s66, s66, 11
    s_add_u32 s66, s66, 3145728
    v_add_u32 v9, s66, v13
    v_add_u32 v248, 1024, v9
    s_mul_i32 s66, s63, 16640
    s_add_u32 s66, s66, 134752
    v_add_u32 v253, s66, v3
    s_lshl_b32 s69, s64, 5
    s_add_u32 s69, s69, s65
    s_lshl_b32 s69, s69, 7
    s_add_u32 s69, s69, 393216
    s_cmp_lt_u32 s65, 29
    s_cselect_b32 s70, 0, 2.0
    s_cmp_lt_u32 s65, 28
    s_cselect_b32 s71, 4096, 2.0
    s_mov_b32 s72, 0
    s_mov_b32 s73, 0
    s_mov_b32 s74, 40960
    s_bfe_u32 s66, s51, 0x10001
    s_or_b32 s62, s62, s66
    s_lshl1_add_u32 s22, s65, 0
    s_lshl_b32 s22, s22, 12
    s_add_u32 s22, s22, 524288
    s_and_b32 s66, s45, 6
    s_and_b32 s67, s46, 1
    s_add_u32 s67, s67, s66
    s_lshl_b32 s67, s67, 9
    s_add_u32 s23, s22, s67
    s_or_b32 s66, s62, s53
    s_cselect_b32 s23, 2.0, s23
    s_mov_b32 s66, 0x3f803f80
    v_mov_b32 v216, s66
    v_mov_b32 v217, s66
    v_mov_b32 v218, s66
    v_mov_b32 v219, s66
    s_mov_b32 s64, 0xffff0000
    s_waitcnt vmcnt(5)
    v_lshlrev_b32 v108, 16, v148
    v_and_b32 v109, s64, v148
    v_lshlrev_b32 v110, 16, v149
    v_and_b32 v111, s64, v149
    v_lshlrev_b32 v112, 16, v150
    v_and_b32 v113, s64, v150
    v_lshlrev_b32 v114, 16, v151
    v_and_b32 v115, s64, v151
    v_lshlrev_b32 v116, 16, v152
    v_and_b32 v117, s64, v152
    v_lshlrev_b32 v118, 16, v153
    v_and_b32 v119, s64, v153
    v_lshlrev_b32 v120, 16, v154
    v_and_b32 v121, s64, v154
    v_lshlrev_b32 v122, 16, v155
    v_and_b32 v123, s64, v155
    v_pk_add_f32 v[124:125], v[108:109], v[110:111]
    v_pk_add_f32 v[126:127], v[112:113], v[114:115]
    v_pk_add_f32 v[128:129], v[116:117], v[118:119]
    v_pk_add_f32 v[130:131], v[120:121], v[122:123]
    v_pk_add_f32 v[124:125], v[124:125], v[126:127]
    v_pk_add_f32 v[128:129], v[128:129], v[130:131]
    v_add_f32 v124, v124, v125
    v_add_f32 v128, v128, v129
    s_nop 0
    v_add_f32_dpp v124, v124, v124 row_shr:1 row_mask:0xf bank_mask:0xf
    v_add_f32_dpp v128, v128, v128 row_shr:1 row_mask:0xf bank_mask:0xf
    s_nop 0
    v_add_f32_dpp v124, v124, v124 row_shr:2 row_mask:0xf bank_mask:0xf
    v_add_f32_dpp v128, v128, v128 row_shr:2 row_mask:0xf bank_mask:0xf
    s_nop 0
    v_add_f32_dpp v124, v124, v124 row_shr:4 row_mask:0xf bank_mask:0xf
    v_add_f32_dpp v128, v128, v128 row_shr:4 row_mask:0xf bank_mask:0xf
    s_nop 0
    v_add_f32_dpp v124, v124, v124 row_shr:8 row_mask:0xf bank_mask:0xf
    v_add_f32_dpp v128, v128, v128 row_shr:8 row_mask:0xf bank_mask:0xf
    s_nop 0
    v_add_f32_dpp v124, v124, v124 row_bcast:15 row_mask:0xa bank_mask:0xf
    v_add_f32_dpp v128, v128, v128 row_bcast:15 row_mask:0xa bank_mask:0xf
    s_nop 0
    v_add_f32_dpp v124, v124, v124 row_bcast:31 row_mask:0xc bank_mask:0xf
    v_add_f32_dpp v128, v128, v128 row_bcast:31 row_mask:0xc bank_mask:0xf
    s_mov_b32 s64, 0x3b000000
    v_mul_f32 v124, s64, v124
    v_mul_f32 v128, s64, v128
    v_readlane_b32 s62, v124, 63
    v_readlane_b32 s63, v128, 63
    s_nop 0
    v_subrev_f32 v108, s62, v108
    v_subrev_f32 v116, s63, v116
    v_subrev_f32 v109, s62, v109
    v_subrev_f32 v117, s63, v117
    v_subrev_f32 v110, s62, v110
    v_subrev_f32 v118, s63, v118
    v_subrev_f32 v111, s62, v111
    v_subrev_f32 v119, s63, v119
    v_subrev_f32 v112, s62, v112
    v_subrev_f32 v120, s63, v120
    v_subrev_f32 v113, s62, v113
    v_subrev_f32 v121, s63, v121
    v_subrev_f32 v114, s62, v114
    v_subrev_f32 v122, s63, v122
    v_subrev_f32 v115, s62, v115
    v_subrev_f32 v123, s63, v123
    v_pk_mul_f32 v[126:127], v[108:109], v[108:109]
    v_pk_mul_f32 v[130:131], v[116:117], v[116:117]
    v_pk_fma_f32 v[126:127], v[110:111], v[110:111], v[126:127]
    v_pk_fma_f32 v[130:131], v[118:119], v[118:119], v[130:131]
    v_pk_fma_f32 v[126:127], v[112:113], v[112:113], v[126:127]
    v_pk_fma_f32 v[130:131], v[120:121], v[120:121], v[130:131]
    v_pk_fma_f32 v[126:127], v[114:115], v[114:115], v[126:127]
    v_pk_fma_f32 v[130:131], v[122:123], v[122:123], v[130:131]
    v_add_f32 v125, v126, v127
    v_add_f32 v129, v130, v131
    s_nop 0
    v_add_f32_dpp v125, v125, v125 row_shr:1 row_mask:0xf bank_mask:0xf
    v_add_f32_dpp v129, v129, v129 row_shr:1 row_mask:0xf bank_mask:0xf
    s_nop 0
    v_add_f32_dpp v125, v125, v125 row_shr:2 row_mask:0xf bank_mask:0xf
    v_add_f32_dpp v129, v129, v129 row_shr:2 row_mask:0xf bank_mask:0xf
    s_nop 0
    v_add_f32_dpp v125, v125, v125 row_shr:4 row_mask:0xf bank_mask:0xf
    v_add_f32_dpp v129, v129, v129 row_shr:4 row_mask:0xf bank_mask:0xf
    s_nop 0
    v_add_f32_dpp v125, v125, v125 row_shr:8 row_mask:0xf bank_mask:0xf
    v_add_f32_dpp v129, v129, v129 row_shr:8 row_mask:0xf bank_mask:0xf
    s_nop 0
    v_add_f32_dpp v125, v125, v125 row_bcast:15 row_mask:0xa bank_mask:0xf
    v_add_f32_dpp v129, v129, v129 row_bcast:15 row_mask:0xa bank_mask:0xf
    s_nop 0
    v_add_f32_dpp v125, v125, v125 row_bcast:31 row_mask:0xc bank_mask:0xf
    v_add_f32_dpp v129, v129, v129 row_bcast:31 row_mask:0xc bank_mask:0xf
    v_mov_b32 v108, 0x3727c5ac
    v_fma_f32 v125, v125, s64, v108
    v_fma_f32 v129, v129, s64, v108
    v_rsq_f32 v125, v125
    v_mov_b32 v126, s48
    v_mov_b32 v127, s49
    v_rsq_f32 v129, v129
    v_mov_b32 v130, s48
    v_mov_b32 v131, s49
    s_lshl_b32 s62, s47, 5
    s_add_u32 s62, s62, 130432
    v_mov_b32 v108, s62
    s_lshl_b64 exec, 1, 63
    ds_write_b128 v108, v[124:127] offset:0
    ds_write_b128 v108, v[128:131] offset:16
    s_mov_b64 exec, -1
    s_waitcnt lgkmcnt(0)
    s_mov_b32 s64, 0xffff0000
    s_waitcnt vmcnt(0)
    s_barrier
    ds_read_b32 v172, v245 offset:640
    ds_read_b32 v173, v245 offset:768
    ds_read_b32 v174, v245 offset:896
    ds_read_b32 v175, v246 offset:1024
    ds_read_b32 v176, v246 offset:1152
    ds_read_b32 v177, v246 offset:1280
    ds_read_b32 v178, v246 offset:1408
    ds_read_b32 v179, v246 offset:1536
    ds_read_b32 v180, v246 offset:1664
    ds_read_b32 v181, v246 offset:1792
    ds_read_b32 v182, v246 offset:1920
    ds_read_b32 v183, v246 offset:9216
    ds_read_b32 v184, v246 offset:9344
    ds_read_b32 v185, v246 offset:9472
    ds_read_b32 v186, v246 offset:9600
    ds_read_b32 v187, v246 offset:9728
    ds_read_b32 v188, v246 offset:9856
    ds_read_b32 v189, v246 offset:9984
    ds_read_b32 v190, v246 offset:10112
    v_lshlrev_b32 v192, 16, v220
    v_and_b32 v194, s64, v220
    v_lshlrev_b32 v196, 16, v221
    v_and_b32 v198, s64, v221
    v_lshlrev_b32 v193, 16, v222
    v_and_b32 v195, s64, v222
    v_lshlrev_b32 v197, 16, v223
    v_and_b32 v199, s64, v223
    s_waitcnt lgkmcnt(8)
    v_lshlrev_b32 v140, 16, v172
    v_and_b32 v141, s64, v172
    v_lshlrev_b32 v142, 16, v173
    v_and_b32 v143, s64, v173
    v_lshlrev_b32 v144, 16, v174
    v_and_b32 v145, s64, v174
    v_lshlrev_b32 v146, 16, v175
    v_and_b32 v147, s64, v175
    v_lshlrev_b32 v148, 16, v176
    v_and_b32 v149, s64, v176
    v_lshlrev_b32 v150, 16, v177
    v_and_b32 v151, s64, v177
    v_lshlrev_b32 v164, 16, v178
    v_and_b32 v165, s64, v178
    v_lshlrev_b32 v166, 16, v179
    v_and_b32 v167, s64, v179
    v_lshlrev_b32 v168, 16, v180
    v_and_b32 v169, s64, v180
    v_lshlrev_b32 v170, 16, v181
    v_and_b32 v171, s64, v181
    v_lshlrev_b32 v224, 16, v182
    v_and_b32 v225, s64, v182
    v_pk_mul_f32 v[200:201], v[140:141], v[198:199]
    v_pk_mul_f32 v[202:203], v[142:143], v[198:199]
    v_pk_mul_f32 v[204:205], v[144:145], v[198:199]
    v_pk_mul_f32 v[206:207], v[146:147], v[198:199]
    v_pk_mul_f32 v[208:209], v[148:149], v[198:199]
    v_pk_mul_f32 v[210:211], v[150:151], v[198:199]
    v_pk_mul_f32 v[212:213], v[164:165], v[198:199]
    v_pk_mul_f32 v[214:215], v[166:167], v[198:199]
    v_pk_fma_f32 v[200:201], v[142:143], v[196:197], v[200:201]
    v_pk_fma_f32 v[202:203], v[144:145], v[196:197], v[202:203]
    v_pk_fma_f32 v[204:205], v[146:147], v[196:197], v[204:205]
    v_pk_fma_f32 v[206:207], v[148:149], v[196:197], v[206:207]
    v_pk_fma_f32 v[208:209], v[150:151], v[196:197], v[208:209]
    v_pk_fma_f32 v[210:211], v[164:165], v[196:197], v[210:211]
    v_pk_fma_f32 v[212:213], v[166:167], v[196:197], v[212:213]
    v_pk_fma_f32 v[214:215], v[168:169], v[196:197], v[214:215]
    v_pk_fma_f32 v[200:201], v[144:145], v[194:195], v[200:201]
    v_pk_fma_f32 v[202:203], v[146:147], v[194:195], v[202:203]
    v_pk_fma_f32 v[204:205], v[148:149], v[194:195], v[204:205]
    v_pk_fma_f32 v[206:207], v[150:151], v[194:195], v[206:207]
    v_pk_fma_f32 v[208:209], v[164:165], v[194:195], v[208:209]
    v_pk_fma_f32 v[210:211], v[166:167], v[194:195], v[210:211]
    v_pk_fma_f32 v[212:213], v[168:169], v[194:195], v[212:213]
    v_pk_fma_f32 v[214:215], v[170:171], v[194:195], v[214:215]
    v_pk_fma_f32 v[200:201], v[146:147], v[192:193], v[200:201]
    v_pk_fma_f32 v[202:203], v[148:149], v[192:193], v[202:203]
    v_pk_fma_f32 v[204:205], v[150:151], v[192:193], v[204:205]
    v_pk_fma_f32 v[206:207], v[164:165], v[192:193], v[206:207]
    v_pk_fma_f32 v[208:209], v[166:167], v[192:193], v[208:209]
    v_pk_fma_f32 v[210:211], v[168:169], v[192:193], v[210:211]
    v_pk_fma_f32 v[212:213], v[170:171], v[192:193], v[212:213]
    v_pk_fma_f32 v[214:215], v[224:225], v[192:193], v[214:215]
    s_waitcnt lgkmcnt(0)
    v_lshlrev_b32 v108, 16, v183
    v_and_b32 v109, s64, v183
    v_lshlrev_b32 v110, 16, v184
    v_and_b32 v111, s64, v184
    v_lshlrev_b32 v112, 16, v185
    v_and_b32 v113, s64, v185
    v_lshlrev_b32 v114, 16, v186
    v_and_b32 v115, s64, v186
    v_lshlrev_b32 v116, 16, v187
    v_and_b32 v117, s64, v187
    v_lshlrev_b32 v118, 16, v188
    v_and_b32 v119, s64, v188
    v_lshlrev_b32 v120, 16, v189
    v_and_b32 v121, s64, v189
    v_lshlrev_b32 v122, 16, v190
    v_and_b32 v123, s64, v190
    v_pk_mul_f32 v[200:201], v[200:201], v[108:109]
    v_pk_mul_f32 v[202:203], v[202:203], v[110:111]
    v_pk_mul_f32 v[204:205], v[204:205], v[112:113]
    v_pk_mul_f32 v[206:207], v[206:207], v[114:115]
    v_pk_mul_f32 v[208:209], v[208:209], v[116:117]
    v_pk_mul_f32 v[210:211], v[210:211], v[118:119]
    v_pk_mul_f32 v[212:213], v[212:213], v[120:121]
    v_pk_mul_f32 v[214:215], v[214:215], v[122:123]
    v_add_u32 v214, 0x10000, v214
    v_and_b32 v214, 0xfffe0000, v214
    v_add_u32 v215, 0x10000, v215
    v_and_b32 v215, 0xfffe0000, v215
    v_cvt_pk_bf16_f32 v236, v214, v212
    v_cvt_pk_bf16_f32 v237, v210, v208
    v_cvt_pk_bf16_f32 v238, v206, v204
    v_cvt_pk_bf16_f32 v239, v202, v200
    v_and_b32 v236, -2, v236
    buffer_store_dwordx4 v[236:239], v247, s[40:43], s0 offen sc1
    v_cvt_pk_bf16_f32 v240, v215, v213
    v_cvt_pk_bf16_f32 v241, v211, v209
    v_cvt_pk_bf16_f32 v242, v207, v205
    v_cvt_pk_bf16_f32 v243, v203, v201
    v_and_b32 v240, -2, v240
    buffer_store_dwordx4 v[240:243], v247, s[40:43], s1 offen sc1
    s_barrier
    s_cmp_lg_u32 s53, 0
    s_cbranch_scc1 recurrent_scan__ssm_conv_h3__glu_gated_bilinear__prompt_kernel_pub
    ds_read_b128 v[108:111], v1 offset:0
    ds_read_b64_tr_b16 v[140:141], v5 offset:0
    ds_read_b64_tr_b16 v[142:143], v5 offset:256
    ds_read_b128 v[112:115], v1 offset:2048
    ds_read_b128 v[116:119], v1 offset:4096
    ds_read_b128 v[120:123], v1 offset:6144
    ds_read_b64_tr_b16 v[144:145], v5 offset:12288
    ds_read_b64_tr_b16 v[146:147], v5 offset:12544
    ds_read_b64_tr_b16 v[148:149], v6 offset:0
    ds_read_b64_tr_b16 v[150:151], v6 offset:256
    s_waitcnt lgkmcnt(7)
    v_mfma_f32_16x16x32_bf16 v[12:15], v[140:143], v[108:111], 0
    ds_read_b64_tr_b16 v[152:153], v6 offset:12288
    s_waitcnt lgkmcnt(7)
    v_mfma_f32_16x16x32_bf16 v[16:19], v[140:143], v[112:115], 0
    ds_read_b64_tr_b16 v[154:155], v6 offset:12544
    s_waitcnt lgkmcnt(7)
    v_mfma_f32_16x16x32_bf16 v[20:23], v[140:143], v[116:119], 0
    ds_read_b64_tr_b16 v[156:157], v5 offset:1024
    s_waitcnt lgkmcnt(7)
    v_mfma_f32_16x16x32_bf16 v[24:27], v[140:143], v[120:123], 0
    ds_read_b64_tr_b16 v[158:159], v5 offset:1280
    v_mfma_f32_16x16x32_bf16 v[164:167], v[216:219], v[140:143], 0
    s_waitcnt lgkmcnt(6)
    v_mfma_f32_16x16x32_bf16 v[28:31], v[144:147], v[108:111], 0
    ds_read_b64_tr_b16 v[160:161], v5 offset:13312
    v_mfma_f32_16x16x32_bf16 v[32:35], v[144:147], v[112:115], 0
    ds_read_b64_tr_b16 v[162:163], v5 offset:13568
    v_mfma_f32_16x16x32_bf16 v[36:39], v[144:147], v[116:119], 0
    ds_read_b64_tr_b16 v[140:141], v5 offset:6144
    v_mfma_f32_16x16x32_bf16 v[40:43], v[144:147], v[120:123], 0
    ds_read_b64_tr_b16 v[142:143], v5 offset:6400
    v_mfma_f32_16x16x32_bf16 v[168:171], v[216:219], v[144:147], 0
    s_waitcnt lgkmcnt(8)
    v_mfma_f32_16x16x32_bf16 v[44:47], v[148:151], v[108:111], 0
    ds_read_b128 v[124:127], v2 offset:0
    v_mfma_f32_16x16x32_bf16 v[48:51], v[148:151], v[112:115], 0
    ds_read_b128 v[128:131], v2 offset:2048
    v_mfma_f32_16x16x32_bf16 v[52:55], v[148:151], v[116:119], 0
    ds_read_b64_tr_b16 v[144:145], v5 offset:18432
    v_mfma_f32_16x16x32_bf16 v[56:59], v[148:151], v[120:123], 0
    ds_read_b64_tr_b16 v[146:147], v5 offset:18688
    v_mfma_f32_16x16x32_bf16 v[172:175], v[216:219], v[148:151], 0
    s_waitcnt lgkmcnt(10)
    v_mfma_f32_16x16x32_bf16 v[60:63], v[152:155], v[108:111], 0
    ds_read_b128 v[132:135], v2 offset:4096
    v_mfma_f32_16x16x32_bf16 v[64:67], v[152:155], v[112:115], 0
    ds_read_b128 v[136:139], v2 offset:6144
    v_mfma_f32_16x16x32_bf16 v[68:71], v[152:155], v[116:119], 0
    ds_read_b64_tr_b16 v[148:149], v6 offset:6144
    v_mfma_f32_16x16x32_bf16 v[72:75], v[152:155], v[120:123], 0
    ds_read_b64_tr_b16 v[150:151], v6 offset:6400
    v_mfma_f32_16x16x32_bf16 v[176:179], v[216:219], v[152:155], 0
    s_waitcnt lgkmcnt(12)
    v_mfma_f32_16x16x32_bf16 v[76:79], v[156:159], v[108:111], 0
    ds_read_b64_tr_b16 v[152:153], v6 offset:18432
    v_mfma_f32_16x16x32_bf16 v[80:83], v[156:159], v[112:115], 0
    ds_read_b64_tr_b16 v[154:155], v6 offset:18688
    v_mfma_f32_16x16x32_bf16 v[84:87], v[156:159], v[116:119], 0
    v_mfma_f32_16x16x32_bf16 v[88:91], v[156:159], v[120:123], 0
    v_mfma_f32_16x16x32_bf16 v[180:183], v[216:219], v[156:159], 0
    s_waitcnt lgkmcnt(12)
    v_mfma_f32_16x16x32_bf16 v[92:95], v[160:163], v[108:111], 0
    ds_read_b64_tr_b16 v[156:157], v5 offset:7168
    v_mfma_f32_16x16x32_bf16 v[96:99], v[160:163], v[112:115], 0
    ds_read_b64_tr_b16 v[158:159], v5 offset:7424
    v_mfma_f32_16x16x32_bf16 v[100:103], v[160:163], v[116:119], 0
    v_mfma_f32_16x16x32_bf16 v[104:107], v[160:163], v[120:123], 0
    v_mfma_f32_16x16x32_bf16 v[184:187], v[216:219], v[160:163], 0
    s_waitcnt lgkmcnt(12)
    s_waitcnt lgkmcnt(11)
    v_mfma_f32_16x16x32_bf16 v[12:15], v[140:143], v[124:127], v[12:15]
    ds_read_b64_tr_b16 v[160:161], v5 offset:19456
    s_waitcnt lgkmcnt(11)
    v_mfma_f32_16x16x32_bf16 v[16:19], v[140:143], v[128:131], v[16:19]
    ds_read_b64_tr_b16 v[162:163], v5 offset:19712
    s_waitcnt lgkmcnt(9)
    v_mfma_f32_16x16x32_bf16 v[20:23], v[140:143], v[132:135], v[20:23]
    s_waitcnt lgkmcnt(8)
    v_mfma_f32_16x16x32_bf16 v[24:27], v[140:143], v[136:139], v[24:27]
    v_mfma_f32_16x16x32_bf16 v[164:167], v[216:219], v[140:143], v[164:167]
    v_mfma_f32_16x16x32_bf16 v[28:31], v[144:147], v[124:127], v[28:31]
    v_add_u32 v1, s74, v1
    v_mfma_f32_16x16x32_bf16 v[32:35], v[144:147], v[128:131], v[32:35]
    v_add_u32 v2, s74, v2
    v_mfma_f32_16x16x32_bf16 v[36:39], v[144:147], v[132:135], v[36:39]
    v_add_u32 v5, s74, v5
    v_mfma_f32_16x16x32_bf16 v[40:43], v[144:147], v[136:139], v[40:43]
    v_add_u32 v6, s74, v6
    v_mfma_f32_16x16x32_bf16 v[168:171], v[216:219], v[144:147], v[168:171]
    s_waitcnt lgkmcnt(6)
    v_mfma_f32_16x16x32_bf16 v[44:47], v[148:151], v[124:127], v[44:47]
    v_mfma_f32_16x16x32_bf16 v[48:51], v[148:151], v[128:131], v[48:51]
    v_mfma_f32_16x16x32_bf16 v[52:55], v[148:151], v[132:135], v[52:55]
    v_mfma_f32_16x16x32_bf16 v[56:59], v[148:151], v[136:139], v[56:59]
    v_mfma_f32_16x16x32_bf16 v[172:175], v[216:219], v[148:151], v[172:175]
    s_waitcnt lgkmcnt(0)
    v_mfma_f32_16x16x32_bf16 v[176:179], v[216:219], v[152:155], v[176:179]
    v_mfma_f32_16x16x32_bf16 v[180:183], v[216:219], v[156:159], v[180:183]
    v_mfma_f32_16x16x32_bf16 v[184:187], v[216:219], v[160:163], v[184:187]
    v_mfma_f32_16x16x32_bf16 v[60:63], v[152:155], v[124:127], v[60:63]
recurrent_scan__ssm_conv_h3__glu_gated_bilinear__prompt_kernel_pub:
    s_waitcnt vmcnt(0)
    v_mov_b32 v250, s48
    v_mov_b32 v251, s49
    v_lshlrev_b32 v252, 3, v0
    s_mov_b64 exec, 0xffff
    buffer_store_dwordx2 v[250:251], v252, s[40:43], s68 offen sc1
    s_mov_b64 exec, -1
    v_and_b32 v4, 16, v0
    v_cmp_eq_u32 vcc, 0, v4
    v_mov_b32 v219, s48
    s_nop 0
    v_cndmask_b32 v216, v168, v164, vcc
    v_cndmask_b32 v217, v176, v172, vcc
    v_cndmask_b32 v218, v184, v180, vcc
    s_mov_b32 exec_hi, 0
    buffer_store_dwordx4 v[216:219], v8, s[40:43], s23 offen sc1
    s_mov_b64 exec, -1
    s_cmp_lg_u32 s47, 1
    s_cbranch_scc1 recurrent_scan__ssm_conv_h3__glu_gated_bilinear__prompt_kernel_sp11
    v_add_u32 v251, 130432, v8
    s_lshl_b32 s62, s45, 5
    s_add_u32 s62, s62, s46
    s_lshl_b32 s62, s62, 7
    s_add_u32 s62, s62, 65536
    s_mov_b64 exec, 0xff
    ds_read_b128 v[228:231], v251
    s_waitcnt lgkmcnt(0)
    buffer_store_dwordx4 v[228:231], v8, s[40:43], s62 offen sc1
    s_mov_b64 exec, -1
recurrent_scan__ssm_conv_h3__glu_gated_bilinear__prompt_kernel_sp11:
    s_cmp_lg_u32 s53, 0
    s_cbranch_scc1 recurrent_scan__ssm_conv_h3__glu_gated_bilinear__prompt_kernel_Cspare
recurrent_scan__ssm_conv_h3__glu_gated_bilinear__prompt_kernel_g1loop:
    s_barrier
    v_mfma_f32_16x16x32_bf16 v[64:67], v[152:155], v[128:131], v[64:67]
    ds_read_b128 v[108:111], v1 offset:0
    v_mfma_f32_16x16x32_bf16 v[68:71], v[152:155], v[132:135], v[68:71]
    ds_read_b64_tr_b16 v[140:141], v5 offset:0
    v_mfma_f32_16x16x32_bf16 v[72:75], v[152:155], v[136:139], v[72:75]
    ds_read_b64_tr_b16 v[142:143], v5 offset:256
    v_mfma_f32_16x16x32_bf16 v[76:79], v[156:159], v[124:127], v[76:79]
    ds_read_b128 v[112:115], v1 offset:2048
    v_mfma_f32_16x16x32_bf16 v[80:83], v[156:159], v[128:131], v[80:83]
    ds_read_b128 v[116:119], v1 offset:4096
    v_mfma_f32_16x16x32_bf16 v[84:87], v[156:159], v[132:135], v[84:87]
    ds_read_b128 v[120:123], v1 offset:6144
    v_mfma_f32_16x16x32_bf16 v[88:91], v[156:159], v[136:139], v[88:91]
    ds_read_b64_tr_b16 v[144:145], v5 offset:12288
    v_mfma_f32_16x16x32_bf16 v[92:95], v[160:163], v[124:127], v[92:95]
    ds_read_b64_tr_b16 v[146:147], v5 offset:12544
    v_mfma_f32_16x16x32_bf16 v[96:99], v[160:163], v[128:131], v[96:99]
    ds_read_b64_tr_b16 v[148:149], v6 offset:0
    v_mfma_f32_16x16x32_bf16 v[100:103], v[160:163], v[132:135], v[100:103]
    ds_read_b64_tr_b16 v[150:151], v6 offset:256
    v_mfma_f32_16x16x32_bf16 v[104:107], v[160:163], v[136:139], v[104:107]
recurrent_scan__ssm_conv_h3__glu_gated_bilinear__prompt_kernel_g1mid:
    s_waitcnt lgkmcnt(7)
    v_mfma_f32_16x16x32_bf16 v[12:15], v[140:143], v[108:111], v[12:15]
    ds_read_b64_tr_b16 v[152:153], v6 offset:12288
    s_waitcnt lgkmcnt(7)
    v_mfma_f32_16x16x32_bf16 v[16:19], v[140:143], v[112:115], v[16:19]
    ds_read_b64_tr_b16 v[154:155], v6 offset:12544
    s_waitcnt lgkmcnt(7)
    v_mfma_f32_16x16x32_bf16 v[20:23], v[140:143], v[116:119], v[20:23]
    ds_read_b64_tr_b16 v[156:157], v5 offset:1024
    s_waitcnt lgkmcnt(7)
    v_mfma_f32_16x16x32_bf16 v[24:27], v[140:143], v[120:123], v[24:27]
    ds_read_b64_tr_b16 v[158:159], v5 offset:1280
    s_waitcnt lgkmcnt(6)
    v_mfma_f32_16x16x32_bf16 v[28:31], v[144:147], v[108:111], v[28:31]
    ds_read_b64_tr_b16 v[160:161], v5 offset:13312
    v_mfma_f32_16x16x32_bf16 v[32:35], v[144:147], v[112:115], v[32:35]
    ds_read_b64_tr_b16 v[162:163], v5 offset:13568
    v_mfma_f32_16x16x32_bf16 v[36:39], v[144:147], v[116:119], v[36:39]
    ds_read_b64_tr_b16 v[140:141], v5 offset:6144
    v_mfma_f32_16x16x32_bf16 v[40:43], v[144:147], v[120:123], v[40:43]
    ds_read_b64_tr_b16 v[142:143], v5 offset:6400
    s_waitcnt lgkmcnt(8)
    v_mfma_f32_16x16x32_bf16 v[44:47], v[148:151], v[108:111], v[44:47]
    ds_read_b128 v[124:127], v2 offset:0
    v_mfma_f32_16x16x32_bf16 v[48:51], v[148:151], v[112:115], v[48:51]
    ds_read_b128 v[128:131], v2 offset:2048
    v_mfma_f32_16x16x32_bf16 v[52:55], v[148:151], v[116:119], v[52:55]
    ds_read_b64_tr_b16 v[144:145], v5 offset:18432
    v_mfma_f32_16x16x32_bf16 v[56:59], v[148:151], v[120:123], v[56:59]
    ds_read_b64_tr_b16 v[146:147], v5 offset:18688
    s_waitcnt lgkmcnt(10)
    v_mfma_f32_16x16x32_bf16 v[60:63], v[152:155], v[108:111], v[60:63]
    ds_read_b128 v[132:135], v2 offset:4096
    v_mfma_f32_16x16x32_bf16 v[64:67], v[152:155], v[112:115], v[64:67]
    ds_read_b128 v[136:139], v2 offset:6144
    v_mfma_f32_16x16x32_bf16 v[68:71], v[152:155], v[116:119], v[68:71]
    ds_read_b64_tr_b16 v[148:149], v6 offset:6144
    v_mfma_f32_16x16x32_bf16 v[72:75], v[152:155], v[120:123], v[72:75]
    ds_read_b64_tr_b16 v[150:151], v6 offset:6400
    s_waitcnt lgkmcnt(12)
    v_mfma_f32_16x16x32_bf16 v[76:79], v[156:159], v[108:111], v[76:79]
    ds_read_b64_tr_b16 v[152:153], v6 offset:18432
    v_mfma_f32_16x16x32_bf16 v[80:83], v[156:159], v[112:115], v[80:83]
    ds_read_b64_tr_b16 v[154:155], v6 offset:18688
    v_mfma_f32_16x16x32_bf16 v[84:87], v[156:159], v[116:119], v[84:87]
    v_mfma_f32_16x16x32_bf16 v[88:91], v[156:159], v[120:123], v[88:91]
    s_waitcnt lgkmcnt(12)
    v_mfma_f32_16x16x32_bf16 v[92:95], v[160:163], v[108:111], v[92:95]
    ds_read_b64_tr_b16 v[156:157], v5 offset:7168
    v_mfma_f32_16x16x32_bf16 v[96:99], v[160:163], v[112:115], v[96:99]
    ds_read_b64_tr_b16 v[158:159], v5 offset:7424
    v_mfma_f32_16x16x32_bf16 v[100:103], v[160:163], v[116:119], v[100:103]
    v_mfma_f32_16x16x32_bf16 v[104:107], v[160:163], v[120:123], v[104:107]
    s_waitcnt lgkmcnt(12)
    s_waitcnt lgkmcnt(11)
    v_mfma_f32_16x16x32_bf16 v[12:15], v[140:143], v[124:127], v[12:15]
    ds_read_b64_tr_b16 v[160:161], v5 offset:19456
    s_waitcnt lgkmcnt(11)
    v_mfma_f32_16x16x32_bf16 v[16:19], v[140:143], v[128:131], v[16:19]
    ds_read_b64_tr_b16 v[162:163], v5 offset:19712
    s_waitcnt lgkmcnt(9)
    v_mfma_f32_16x16x32_bf16 v[20:23], v[140:143], v[132:135], v[20:23]
    s_add_u32 s72, s72, 1
    s_waitcnt lgkmcnt(8)
    v_mfma_f32_16x16x32_bf16 v[24:27], v[140:143], v[136:139], v[24:27]
    s_bitcmp1_b32 36, s72
    v_mfma_f32_16x16x32_bf16 v[28:31], v[144:147], v[124:127], v[28:31]
    s_cselect_b32 s67, -81920, s74
    v_mfma_f32_16x16x32_bf16 v[32:35], v[144:147], v[128:131], v[32:35]
    s_bitcmp0_b32 96, s72
    v_mfma_f32_16x16x32_bf16 v[36:39], v[144:147], v[132:135], v[36:39]
    v_add_u32 v1, s67, v1
    v_mfma_f32_16x16x32_bf16 v[40:43], v[144:147], v[136:139], v[40:43]
    v_add_u32 v2, s67, v2
    s_waitcnt lgkmcnt(6)
    v_mfma_f32_16x16x32_bf16 v[44:47], v[148:151], v[124:127], v[44:47]
    v_add_u32 v5, s67, v5
    v_mfma_f32_16x16x32_bf16 v[48:51], v[148:151], v[128:131], v[48:51]
    v_add_u32 v6, s67, v6
    v_mfma_f32_16x16x32_bf16 v[52:55], v[148:151], v[132:135], v[52:55]
    v_mfma_f32_16x16x32_bf16 v[56:59], v[148:151], v[136:139], v[56:59]
    s_waitcnt lgkmcnt(4)
    v_mfma_f32_16x16x32_bf16 v[60:63], v[152:155], v[124:127], v[60:63]
    s_waitcnt lgkmcnt(0)
    s_cbranch_scc1 recurrent_scan__ssm_conv_h3__glu_gated_bilinear__prompt_kernel_g1loop
    s_barrier
    v_mfma_f32_16x16x32_bf16 v[64:67], v[152:155], v[128:131], v[64:67]
    ds_read_b128 v[108:111], v1 offset:0
    v_mfma_f32_16x16x32_bf16 v[68:71], v[152:155], v[132:135], v[68:71]
    ds_read_b64_tr_b16 v[140:141], v5 offset:0
    v_mfma_f32_16x16x32_bf16 v[72:75], v[152:155], v[136:139], v[72:75]
    ds_read_b64_tr_b16 v[142:143], v5 offset:256
    v_mfma_f32_16x16x32_bf16 v[76:79], v[156:159], v[124:127], v[76:79]
    ds_read_b128 v[112:115], v1 offset:2048
    ds_read_b128 v[164:167], v253 offset:0
    v_mfma_f32_16x16x32_bf16 v[80:83], v[156:159], v[128:131], v[80:83]
    ds_read_b128 v[116:119], v1 offset:4096
    v_mfma_f32_16x16x32_bf16 v[84:87], v[156:159], v[132:135], v[84:87]
    ds_read_b128 v[120:123], v1 offset:6144
    ds_read_b128 v[168:171], v253 offset:2048
    v_mfma_f32_16x16x32_bf16 v[88:91], v[156:159], v[136:139], v[88:91]
    ds_read_b64_tr_b16 v[144:145], v5 offset:12288
    v_mfma_f32_16x16x32_bf16 v[92:95], v[160:163], v[124:127], v[92:95]
    ds_read_b64_tr_b16 v[146:147], v5 offset:12544
    ds_read_b128 v[172:175], v253 offset:256
    v_mfma_f32_16x16x32_bf16 v[96:99], v[160:163], v[128:131], v[96:99]
    ds_read_b64_tr_b16 v[148:149], v6 offset:0
    v_mfma_f32_16x16x32_bf16 v[100:103], v[160:163], v[132:135], v[100:103]
    ds_read_b64_tr_b16 v[150:151], v6 offset:256
    ds_read_b128 v[176:179], v253 offset:2304
    v_mfma_f32_16x16x32_bf16 v[104:107], v[160:163], v[136:139], v[104:107]
    ds_read_b128 v[180:183], v249 offset:0
    ds_read_b128 v[184:187], v249 offset:256
    ds_read_b128 v[188:191], v249 offset:512
    ds_read_b128 v[192:195], v249 offset:768
    s_waitcnt lgkmcnt(15)
    v_mfma_f32_16x16x32_bf16 v[12:15], v[140:143], v[108:111], v[12:15]
    ds_read_b64_tr_b16 v[152:153], v6 offset:12288
    s_waitcnt lgkmcnt(15)
    v_mfma_f32_16x16x32_bf16 v[16:19], v[140:143], v[112:115], v[16:19]
    ds_read_b64_tr_b16 v[154:155], v6 offset:12544
    s_waitcnt lgkmcnt(14)
    v_mfma_f32_16x16x32_bf16 v[20:23], v[140:143], v[116:119], v[20:23]
    ds_read_b64_tr_b16 v[156:157], v5 offset:1024
    s_waitcnt lgkmcnt(3)
    v_mfma_f32_16x16x32_bf16 v[24:27], v[140:143], v[120:123], v[24:27]
    ds_read_b64_tr_b16 v[158:159], v5 offset:1280
    v_mfma_f32_16x16x32_bf16 v[28:31], v[144:147], v[108:111], v[28:31]
    ds_read_b64_tr_b16 v[160:161], v5 offset:13312
    v_xor_b32 v236, s48, v167
    v_mfma_f32_16x16x32_bf16 v[32:35], v[144:147], v[112:115], v[32:35]
    ds_read_b64_tr_b16 v[162:163], v5 offset:13568
    v_mfma_f32_16x16x32_bf16 v[36:39], v[144:147], v[116:119], v[36:39]
    ds_read_b64_tr_b16 v[140:141], v5 offset:6144
    v_xor_b32 v237, s48, v171
    v_mfma_f32_16x16x32_bf16 v[40:43], v[144:147], v[120:123], v[40:43]
    ds_read_b64_tr_b16 v[142:143], v5 offset:6400
    v_mfma_f32_16x16x32_bf16 v[44:47], v[148:151], v[108:111], v[44:47]
    ds_read_b128 v[124:127], v2 offset:0
    v_xor_b32 v238, s48, v175
    v_mfma_f32_16x16x32_bf16 v[48:51], v[148:151], v[112:115], v[48:51]
    ds_read_b128 v[128:131], v2 offset:2048
    v_mfma_f32_16x16x32_bf16 v[52:55], v[148:151], v[116:119], v[52:55]
    ds_read_b64_tr_b16 v[144:145], v5 offset:18432
    v_or3_b32 v236, v236, v237, v238
    v_mfma_f32_16x16x32_bf16 v[56:59], v[148:151], v[120:123], v[56:59]
    ds_read_b64_tr_b16 v[146:147], v5 offset:18688
    s_waitcnt lgkmcnt(10)
    v_mfma_f32_16x16x32_bf16 v[60:63], v[152:155], v[108:111], v[60:63]
    ds_read_b128 v[132:135], v2 offset:4096
    v_xor_b32 v237, s48, v179
    v_mfma_f32_16x16x32_bf16 v[64:67], v[152:155], v[112:115], v[64:67]
    ds_read_b128 v[136:139], v2 offset:6144
    v_mfma_f32_16x16x32_bf16 v[68:71], v[152:155], v[116:119], v[68:71]
    ds_read_b64_tr_b16 v[148:149], v6 offset:6144
    v_xor_b32 v238, s48, v182
    v_mfma_f32_16x16x32_bf16 v[72:75], v[152:155], v[120:123], v[72:75]
    ds_read_b64_tr_b16 v[150:151], v6 offset:6400
    s_waitcnt lgkmcnt(12)
    v_mfma_f32_16x16x32_bf16 v[76:79], v[156:159], v[108:111], v[76:79]
    ds_read_b64_tr_b16 v[152:153], v6 offset:18432
    v_or3_b32 v236, v236, v237, v238
    v_mfma_f32_16x16x32_bf16 v[80:83], v[156:159], v[112:115], v[80:83]
    ds_read_b64_tr_b16 v[154:155], v6 offset:18688
    v_mfma_f32_16x16x32_bf16 v[84:87], v[156:159], v[116:119], v[84:87]
    v_xor_b32 v237, s49, v183
    v_xor_b32 v238, s48, v186
    v_mfma_f32_16x16x32_bf16 v[88:91], v[156:159], v[120:123], v[88:91]
    v_or3_b32 v236, v236, v237, v238
    s_waitcnt lgkmcnt(12)
    v_mfma_f32_16x16x32_bf16 v[92:95], v[160:163], v[108:111], v[92:95]
    ds_read_b64_tr_b16 v[156:157], v5 offset:7168
    v_xor_b32 v237, s49, v187
    v_mfma_f32_16x16x32_bf16 v[96:99], v[160:163], v[112:115], v[96:99]
    ds_read_b64_tr_b16 v[158:159], v5 offset:7424
    v_mfma_f32_16x16x32_bf16 v[100:103], v[160:163], v[116:119], v[100:103]
    v_xor_b32 v238, s48, v190
    v_or3_b32 v236, v236, v237, v238
    v_mfma_f32_16x16x32_bf16 v[104:107], v[160:163], v[120:123], v[104:107]
    v_xor_b32 v237, s49, v191
    s_waitcnt lgkmcnt(12)
    s_waitcnt lgkmcnt(11)
    v_mfma_f32_16x16x32_bf16 v[12:15], v[140:143], v[124:127], v[12:15]
    ds_read_b64_tr_b16 v[160:161], v5 offset:19456
    v_xor_b32 v238, s48, v194
    s_waitcnt lgkmcnt(11)
    v_mfma_f32_16x16x32_bf16 v[16:19], v[140:143], v[128:131], v[16:19]
    ds_read_b64_tr_b16 v[162:163], v5 offset:19712
    s_waitcnt lgkmcnt(9)
    v_mfma_f32_16x16x32_bf16 v[20:23], v[140:143], v[132:135], v[20:23]
    v_or3_b32 v236, v236, v237, v238
    v_xor_b32 v237, s49, v195
    s_waitcnt lgkmcnt(8)
    v_mfma_f32_16x16x32_bf16 v[24:27], v[140:143], v[136:139], v[24:27]
    v_or_b32 v236, v236, v237
    v_mfma_f32_16x16x32_bf16 v[28:31], v[144:147], v[124:127], v[28:31]
    v_cmp_ne_u32 vcc, 0, v236
    s_nop 1
    s_cmp_lg_u64 vcc, 0
    v_mfma_f32_16x16x32_bf16 v[32:35], v[144:147], v[128:131], v[32:35]
    s_cbranch_scc1 recurrent_scan__ssm_conv_h3__glu_gated_bilinear__prompt_kernel_grslow
recurrent_scan__ssm_conv_h3__glu_gated_bilinear__prompt_kernel_grok:
    v_mfma_f32_16x16x32_bf16 v[36:39], v[144:147], v[132:135], v[36:39]
    v_add_f32 v196, v164, v168
    v_add_f32 v198, v172, v176
    v_mfma_f32_16x16x32_bf16 v[40:43], v[144:147], v[136:139], v[40:43]
    v_add_f32 v200, v165, v169
    s_waitcnt lgkmcnt(6)
    v_mfma_f32_16x16x32_bf16 v[44:47], v[148:151], v[124:127], v[44:47]
    v_add_f32 v202, v173, v177
    v_add_f32 v204, v166, v170
    v_mfma_f32_16x16x32_bf16 v[48:51], v[148:151], v[128:131], v[48:51]
    v_add_f32 v206, v174, v178
    v_mfma_f32_16x16x32_bf16 v[52:55], v[148:151], v[132:135], v[52:55]
    v_cvt_pk_bf16_f32 v208, -v180, -v180
    v_lshlrev_b32 v209, 16, v208
    v_mfma_f32_16x16x32_bf16 v[56:59], v[148:151], v[136:139], v[56:59]
    v_add_f32 v209, v209, v180
    s_waitcnt lgkmcnt(4)
    v_mfma_f32_16x16x32_bf16 v[60:63], v[152:155], v[124:127], v[60:63]
    v_cvt_pk_bf16_f32 v209, -v209, -v209
    v_cvt_pk_bf16_f32 v210, -v184, -v184
    v_lshlrev_b32 v211, 16, v210
    v_add_f32 v211, v211, v184
    v_cvt_pk_bf16_f32 v211, -v211, -v211
    v_cvt_pk_bf16_f32 v212, -v188, -v188
    v_lshlrev_b32 v213, 16, v212
    v_add_f32 v213, v213, v188
    v_cvt_pk_bf16_f32 v213, -v213, -v213
    v_cvt_pk_bf16_f32 v214, -v192, -v192
    v_lshlrev_b32 v215, 16, v214
    v_add_f32 v215, v215, v192
    v_cvt_pk_bf16_f32 v215, -v215, -v215
    v_add_u32 v1, s74, v1
    v_add_u32 v2, s74, v2
    v_add_u32 v5, s74, v5
    v_add_u32 v6, s74, v6
    s_waitcnt lgkmcnt(0)
    s_barrier
    v_mfma_f32_16x16x32_bf16 v[64:67], v[152:155], v[128:131], v[64:67]
    ds_read_b128 v[108:111], v1 offset:0
    v_mfma_f32_16x16x32_bf16 v[68:71], v[152:155], v[132:135], v[68:71]
    ds_read_b128 v[112:115], v1 offset:2048
    v_mfma_f32_16x16x32_bf16 v[72:75], v[152:155], v[136:139], v[72:75]
    ds_read_b64_tr_b16 v[140:141], v5 offset:0
    v_mfma_f32_16x16x32_bf16 v[76:79], v[156:159], v[124:127], v[76:79]
    ds_read_b64_tr_b16 v[142:143], v5 offset:256
    v_mfma_f32_16x16x32_bf16 v[80:83], v[156:159], v[128:131], v[80:83]
    ds_read_b64_tr_b16 v[144:145], v5 offset:12288
    v_mfma_f32_16x16x32_bf16 v[84:87], v[156:159], v[132:135], v[84:87]
    ds_read_b64_tr_b16 v[146:147], v5 offset:12544
    v_mfma_f32_16x16x32_bf16 v[88:91], v[156:159], v[136:139], v[88:91]
    ds_read_b128 v[164:167], v2 offset:0
    v_mfma_f32_16x16x32_bf16 v[92:95], v[160:163], v[124:127], v[92:95]
    ds_read_b128 v[168:171], v2 offset:2048
    v_mfma_f32_16x16x32_bf16 v[96:99], v[160:163], v[128:131], v[96:99]
    ds_read_b64_tr_b16 v[148:149], v5 offset:6144
    v_mfma_f32_16x16x32_bf16 v[100:103], v[160:163], v[132:135], v[100:103]
    ds_read_b64_tr_b16 v[150:151], v5 offset:6400
    v_mfma_f32_16x16x32_bf16 v[104:107], v[160:163], v[136:139], v[104:107]
    ds_read_b64_tr_b16 v[180:181], v5 offset:18432
    v_cvt_pk_bf16_f32 v197, v196, v196
    v_lshlrev_b32 v197, 16, v197
    v_sub_f32 v197, v196, v197
    v_cvt_pk_bf16_f32 v196, v196, v197
    v_mov_b32 v197, v196
    v_cvt_pk_bf16_f32 v199, v198, v198
    v_lshlrev_b32 v199, 16, v199
    v_sub_f32 v199, v198, v199
    v_cvt_pk_bf16_f32 v198, v198, v199
    v_mov_b32 v199, v198
    v_mfma_f32_16x16x16_bf16 v[12:15], v[196:197], v[208:209], v[12:15]
    ds_read_b64_tr_b16 v[182:183], v5 offset:18688
    v_mfma_f32_16x16x16_bf16 v[28:31], v[198:199], v[208:209], v[28:31]
    ds_read_b128 v[116:119], v1 offset:4096
    v_mfma_f32_16x16x16_bf16 v[16:19], v[196:197], v[210:211], v[16:19]
    ds_read_b128 v[120:123], v1 offset:6144
    v_mfma_f32_16x16x16_bf16 v[32:35], v[198:199], v[210:211], v[32:35]
    ds_read_b128 v[172:175], v2 offset:4096
    s_waitcnt lgkmcnt(11)
    v_mfma_f32_16x16x32_bf16 v[12:15], v[140:143], v[108:111], v[12:15]
    ds_read_b128 v[176:179], v2 offset:6144
    s_waitcnt lgkmcnt(10)
    v_mfma_f32_16x16x32_bf16 v[28:31], v[144:147], v[108:111], v[28:31]
    ds_read_b64_tr_b16 v[184:185], v6 offset:0
    v_mfma_f32_16x16x32_bf16 v[16:19], v[140:143], v[112:115], v[16:19]
    ds_read_b64_tr_b16 v[186:187], v6 offset:256
    v_mfma_f32_16x16x32_bf16 v[32:35], v[144:147], v[112:115], v[32:35]
    ds_read_b64_tr_b16 v[188:189], v6 offset:12288
    s_waitcnt lgkmcnt(9)
    v_mfma_f32_16x16x32_bf16 v[12:15], v[148:151], v[164:167], v[12:15]
    ds_read_b64_tr_b16 v[190:191], v6 offset:12544
    s_waitcnt lgkmcnt(8)
    v_mfma_f32_16x16x32_bf16 v[28:31], v[180:183], v[164:167], v[28:31]
    ds_read_b64_tr_b16 v[192:193], v6 offset:6144
    v_mfma_f32_16x16x32_bf16 v[16:19], v[148:151], v[168:171], v[16:19]
    ds_read_b64_tr_b16 v[194:195], v6 offset:6400
    v_mfma_f32_16x16x32_bf16 v[32:35], v[180:183], v[168:171], v[32:35]
    ds_read_b64_tr_b16 v[216:217], v6 offset:18432
    v_mfma_f32_16x16x16_bf16 v[20:23], v[196:197], v[212:213], v[20:23]
    ds_read_b64_tr_b16 v[218:219], v6 offset:18688
    v_mfma_f32_16x16x16_bf16 v[36:39], v[198:199], v[212:213], v[36:39]
    ds_read_b64_tr_b16 v[220:221], v5 offset:1024
    v_mfma_f32_16x16x16_bf16 v[24:27], v[196:197], v[214:215], v[24:27]
    ds_read_b64_tr_b16 v[222:223], v5 offset:1280
    v_mfma_f32_16x16x16_bf16 v[40:43], v[198:199], v[214:215], v[40:43]
    ds_read_b64_tr_b16 v[224:225], v5 offset:13312
    s_waitcnt lgkmcnt(14)
    v_mfma_f32_16x16x32_bf16 v[20:23], v[140:143], v[116:119], v[20:23]
    ds_read_b64_tr_b16 v[226:227], v5 offset:13568
    v_mfma_f32_16x16x32_bf16 v[36:39], v[144:147], v[116:119], v[36:39]
    ds_read_b64_tr_b16 v[228:229], v5 offset:7168
    s_waitcnt lgkmcnt(15)
    v_mfma_f32_16x16x32_bf16 v[24:27], v[140:143], v[120:123], v[24:27]
    ds_read_b64_tr_b16 v[230:231], v5 offset:7424
    v_mfma_f32_16x16x32_bf16 v[40:43], v[144:147], v[120:123], v[40:43]
    ds_read_b64_tr_b16 v[152:153], v5 offset:19456
    s_waitcnt lgkmcnt(15)
    v_mfma_f32_16x16x32_bf16 v[20:23], v[148:151], v[172:175], v[20:23]
    ds_read_b64_tr_b16 v[154:155], v5 offset:19712
    v_mfma_f32_16x16x32_bf16 v[36:39], v[180:183], v[172:175], v[36:39]
    v_mul_f32 v12, v12, v28
    v_mfma_f32_16x16x32_bf16 v[24:27], v[148:151], v[176:179], v[24:27]
    v_mul_f32 v13, v13, v29
    v_mfma_f32_16x16x32_bf16 v[40:43], v[180:183], v[176:179], v[40:43]
    v_mul_f32 v14, v14, v30
    v_mul_f32 v15, v15, v31
    v_cvt_pk_bf16_f32 v240, v12, v13
    v_cvt_pk_bf16_f32 v241, v14, v15
    v_mul_f32 v16, v16, v32
    v_mul_f32 v17, v17, v33
    v_mul_f32 v18, v18, v34
    v_mul_f32 v19, v19, v35
    v_cvt_pk_bf16_f32 v242, v16, v17
    v_cvt_pk_bf16_f32 v243, v18, v19
    s_nop 0
    v_permlane32_swap_b32 v240, v242
    v_permlane32_swap_b32 v241, v243
    buffer_store_dwordx4 v[240:243], v9, s[40:43], s70 offen offset:0 sc1
    v_cvt_pk_bf16_f32 v201, v200, v200
    v_lshlrev_b32 v201, 16, v201
    v_sub_f32 v201, v200, v201
    v_cvt_pk_bf16_f32 v200, v200, v201
    v_mov_b32 v201, v200
    v_cvt_pk_bf16_f32 v203, v202, v202
    v_lshlrev_b32 v203, 16, v203
    v_sub_f32 v203, v202, v203
    v_cvt_pk_bf16_f32 v202, v202, v203
    v_mov_b32 v203, v202
    v_mfma_f32_16x16x16_bf16 v[44:47], v[200:201], v[208:209], v[44:47]
    v_cvt_pk_bf16_f32 v205, v204, v204
    v_mfma_f32_16x16x16_bf16 v[60:63], v[202:203], v[208:209], v[60:63]
    v_lshlrev_b32 v205, 16, v205
    v_mfma_f32_16x16x16_bf16 v[48:51], v[200:201], v[210:211], v[48:51]
    v_mul_f32 v20, v20, v36
    v_mfma_f32_16x16x16_bf16 v[64:67], v[202:203], v[210:211], v[64:67]
    v_mul_f32 v21, v21, v37
    s_waitcnt lgkmcnt(14)
    v_mfma_f32_16x16x32_bf16 v[44:47], v[184:187], v[108:111], v[44:47]
    v_mul_f32 v22, v22, v38
    s_waitcnt lgkmcnt(12)
    v_mfma_f32_16x16x32_bf16 v[60:63], v[188:191], v[108:111], v[60:63]
    v_mul_f32 v23, v23, v39
    v_mfma_f32_16x16x32_bf16 v[48:51], v[184:187], v[112:115], v[48:51]
    v_cvt_pk_bf16_f32 v244, v20, v21
    v_mfma_f32_16x16x32_bf16 v[64:67], v[188:191], v[112:115], v[64:67]
    v_cvt_pk_bf16_f32 v245, v22, v23
    s_waitcnt lgkmcnt(10)
    v_mfma_f32_16x16x32_bf16 v[44:47], v[192:195], v[164:167], v[44:47]
    v_mul_f32 v24, v24, v40
    s_waitcnt lgkmcnt(8)
    v_mfma_f32_16x16x32_bf16 v[60:63], v[216:219], v[164:167], v[60:63]
    v_mul_f32 v25, v25, v41
    v_mfma_f32_16x16x32_bf16 v[48:51], v[192:195], v[168:171], v[48:51]
    v_mul_f32 v26, v26, v42
    v_mfma_f32_16x16x32_bf16 v[64:67], v[216:219], v[168:171], v[64:67]
    v_mul_f32 v27, v27, v43
    v_cvt_pk_bf16_f32 v246, v24, v25
    v_cvt_pk_bf16_f32 v247, v26, v27
    s_nop 0
    v_permlane32_swap_b32 v244, v246
    v_permlane32_swap_b32 v245, v247
    buffer_store_dwordx4 v[244:247], v248, s[40:43], s70 offen offset:0 sc1
    v_mfma_f32_16x16x16_bf16 v[52:55], v[200:201], v[212:213], v[52:55]
    v_sub_f32 v205, v204, v205
    v_mfma_f32_16x16x16_bf16 v[68:71], v[202:203], v[212:213], v[68:71]
    v_cvt_pk_bf16_f32 v204, v204, v205
    v_mfma_f32_16x16x16_bf16 v[56:59], v[200:201], v[214:215], v[56:59]
    v_mul_f32 v44, v44, v60
    v_mfma_f32_16x16x16_bf16 v[72:75], v[202:203], v[214:215], v[72:75]
    v_mul_f32 v45, v45, v61
    v_mfma_f32_16x16x32_bf16 v[52:55], v[184:187], v[116:119], v[52:55]
    v_mul_f32 v46, v46, v62
    v_mfma_f32_16x16x32_bf16 v[68:71], v[188:191], v[116:119], v[68:71]
    v_mul_f32 v47, v47, v63
    v_mfma_f32_16x16x32_bf16 v[56:59], v[184:187], v[120:123], v[56:59]
    v_cvt_pk_bf16_f32 v236, v44, v45
    v_mfma_f32_16x16x32_bf16 v[72:75], v[188:191], v[120:123], v[72:75]
    v_cvt_pk_bf16_f32 v237, v46, v47
    v_mfma_f32_16x16x32_bf16 v[52:55], v[192:195], v[172:175], v[52:55]
    v_mul_f32 v48, v48, v64
    v_mfma_f32_16x16x32_bf16 v[68:71], v[216:219], v[172:175], v[68:71]
    v_mul_f32 v49, v49, v65
    v_mfma_f32_16x16x32_bf16 v[56:59], v[192:195], v[176:179], v[56:59]
    v_mul_f32 v50, v50, v66
    v_mfma_f32_16x16x32_bf16 v[72:75], v[216:219], v[176:179], v[72:75]
    v_mul_f32 v51, v51, v67
    v_cvt_pk_bf16_f32 v238, v48, v49
    v_cvt_pk_bf16_f32 v239, v50, v51
    s_nop 0
    v_permlane32_swap_b32 v236, v238
    v_permlane32_swap_b32 v237, v239
    buffer_store_dwordx4 v[236:239], v9, s[40:43], s70 offen offset:2048 sc1
    v_mov_b32 v205, v204
    v_cvt_pk_bf16_f32 v207, v206, v206
    v_lshlrev_b32 v207, 16, v207
    v_sub_f32 v207, v206, v207
    v_cvt_pk_bf16_f32 v206, v206, v207
    v_mov_b32 v207, v206
    v_mfma_f32_16x16x16_bf16 v[76:79], v[204:205], v[208:209], v[76:79]
    s_nop 0
    v_mfma_f32_16x16x16_bf16 v[92:95], v[206:207], v[208:209], v[92:95]
    v_mfma_f32_16x16x16_bf16 v[80:83], v[204:205], v[210:211], v[80:83]
    v_mul_f32 v52, v52, v68
    v_mfma_f32_16x16x16_bf16 v[96:99], v[206:207], v[210:211], v[96:99]
    v_mul_f32 v53, v53, v69
    s_waitcnt lgkmcnt(6)
    v_mfma_f32_16x16x32_bf16 v[76:79], v[220:223], v[108:111], v[76:79]
    v_mul_f32 v54, v54, v70
    s_waitcnt lgkmcnt(4)
    v_mfma_f32_16x16x32_bf16 v[92:95], v[224:227], v[108:111], v[92:95]
    v_mul_f32 v55, v55, v71
    v_mfma_f32_16x16x32_bf16 v[80:83], v[220:223], v[112:115], v[80:83]
    v_cvt_pk_bf16_f32 v240, v52, v53
    v_mfma_f32_16x16x32_bf16 v[96:99], v[224:227], v[112:115], v[96:99]
    v_cvt_pk_bf16_f32 v241, v54, v55
    s_waitcnt lgkmcnt(2)
    v_mfma_f32_16x16x32_bf16 v[76:79], v[228:231], v[164:167], v[76:79]
    v_mul_f32 v56, v56, v72
    s_waitcnt lgkmcnt(0)
    v_mfma_f32_16x16x32_bf16 v[92:95], v[152:155], v[164:167], v[92:95]
    v_mul_f32 v57, v57, v73
    v_mfma_f32_16x16x32_bf16 v[80:83], v[228:231], v[168:171], v[80:83]
    v_mul_f32 v58, v58, v74
    v_mfma_f32_16x16x32_bf16 v[96:99], v[152:155], v[168:171], v[96:99]
    v_mul_f32 v59, v59, v75
    v_cvt_pk_bf16_f32 v242, v56, v57
    v_cvt_pk_bf16_f32 v243, v58, v59
    s_nop 0
    v_permlane32_swap_b32 v240, v242
    v_permlane32_swap_b32 v241, v243
    buffer_store_dwordx4 v[240:243], v248, s[40:43], s70 offen offset:2048 sc1
    v_mfma_f32_16x16x16_bf16 v[84:87], v[204:205], v[212:213], v[84:87]
    v_mfma_f32_16x16x16_bf16 v[100:103], v[206:207], v[212:213], v[100:103]
    v_mfma_f32_16x16x16_bf16 v[88:91], v[204:205], v[214:215], v[88:91]
    v_mul_f32 v76, v76, v92
    v_mfma_f32_16x16x16_bf16 v[104:107], v[206:207], v[214:215], v[104:107]
    v_mul_f32 v77, v77, v93
    v_mfma_f32_16x16x32_bf16 v[84:87], v[220:223], v[116:119], v[84:87]
    v_mul_f32 v78, v78, v94
    v_mfma_f32_16x16x32_bf16 v[100:103], v[224:227], v[116:119], v[100:103]
    v_mul_f32 v79, v79, v95
    v_mfma_f32_16x16x32_bf16 v[88:91], v[220:223], v[120:123], v[88:91]
    v_cvt_pk_bf16_f32 v244, v76, v77
    v_mfma_f32_16x16x32_bf16 v[104:107], v[224:227], v[120:123], v[104:107]
    v_cvt_pk_bf16_f32 v245, v78, v79
    v_mfma_f32_16x16x32_bf16 v[84:87], v[228:231], v[172:175], v[84:87]
    v_mul_f32 v80, v80, v96
    v_mfma_f32_16x16x32_bf16 v[100:103], v[152:155], v[172:175], v[100:103]
    v_mul_f32 v81, v81, v97
    v_mfma_f32_16x16x32_bf16 v[88:91], v[228:231], v[176:179], v[88:91]
    v_mul_f32 v82, v82, v98
    v_mfma_f32_16x16x32_bf16 v[104:107], v[152:155], v[176:179], v[104:107]
    v_mul_f32 v83, v83, v99
    v_cvt_pk_bf16_f32 v246, v80, v81
    v_cvt_pk_bf16_f32 v247, v82, v83
    s_nop 0
    v_permlane32_swap_b32 v244, v246
    v_permlane32_swap_b32 v245, v247
    buffer_store_dwordx4 v[244:247], v9, s[40:43], s71 offen offset:0 sc1
    v_mul_f32 v84, v84, v100
    v_mul_f32 v85, v85, v101
    v_mul_f32 v86, v86, v102
    v_mul_f32 v87, v87, v103
    v_cvt_pk_bf16_f32 v236, v84, v85
    v_cvt_pk_bf16_f32 v237, v86, v87
    v_mul_f32 v88, v88, v104
    v_mul_f32 v89, v89, v105
    v_mul_f32 v90, v90, v106
    v_mul_f32 v91, v91, v107
    v_cvt_pk_bf16_f32 v238, v88, v89
    v_cvt_pk_bf16_f32 v239, v90, v91
    s_nop 0
    v_permlane32_swap_b32 v236, v238
    v_permlane32_swap_b32 v237, v239
    buffer_store_dwordx4 v[236:239], v248, s[40:43], s71 offen offset:0 sc1
    v_mov_b32 v251, 1
    ds_write_b32 v255, v251 offset:8320
recurrent_scan__ssm_conv_h3__glu_gated_bilinear__prompt_kernel_conv:
    v_xor_b32 v254, 4, v255
    v_and_b32 v2, 4, v0
    v_xor_b32 v2, v2, v255
    s_mov_b32 s57, 3200000
recurrent_scan__ssm_conv_h3__glu_gated_bilinear__prompt_kernel_xl12:
    ds_read_b32 v3, v2 offset:0
    s_waitcnt lgkmcnt(0)
    v_cmp_ne_u32 vcc, 1, v3
    s_nop 1
    s_cmp_eq_u64 vcc, 0
    s_cbranch_scc1 recurrent_scan__ssm_conv_h3__glu_gated_bilinear__prompt_kernel_xd13
    s_sleep 1
    s_sub_u32 s57, s57, 1
    s_cbranch_scc0 recurrent_scan__ssm_conv_h3__glu_gated_bilinear__prompt_kernel_xl12
recurrent_scan__ssm_conv_h3__glu_gated_bilinear__prompt_kernel_xd13:
    ds_read_b128 v[44:47], v11 offset:192
    ds_read_b128 v[48:51], v11 offset:704
    ds_read_b128 v[52:55], v11 offset:1216
    ds_read_b128 v[56:59], v11 offset:1728
    ds_read_b128 v[60:63], v11 offset:2240
    ds_read_b128 v[64:67], v11 offset:2752
    ds_read_b128 v[68:71], v11 offset:3264
    ds_read_b128 v[72:75], v11 offset:3776
    ds_read_b64 v[12:13], v10 offset:0
    ds_read_b64 v[14:15], v10 offset:8
    ds_read_b64 v[16:17], v10 offset:512
    ds_read_b64 v[18:19], v10 offset:520
    ds_read_b64 v[20:21], v10 offset:1024
    ds_read_b64 v[22:23], v10 offset:1032
    ds_read_b64 v[24:25], v10 offset:1536
    ds_read_b64 v[26:27], v10 offset:1544
    ds_read_b64 v[28:29], v10 offset:2048
    ds_read_b64 v[30:31], v10 offset:2056
    ds_read_b64 v[32:33], v10 offset:2560
    ds_read_b64 v[34:35], v10 offset:2568
    ds_read_b64 v[36:37], v10 offset:3072
    ds_read_b64 v[38:39], v10 offset:3080
    ds_read_b64 v[40:41], v10 offset:3584
    ds_read_b64 v[42:43], v10 offset:3592
    s_waitcnt lgkmcnt(15)
    v_mfma_f32_16x16x32_bf16 v[108:111], v[232:235], v[44:47], 0
    v_mfma_f32_16x16x32_bf16 v[112:115], v[232:235], v[48:51], 0
    v_mfma_f32_16x16x32_bf16 v[116:119], v[232:235], v[52:55], 0
    v_mfma_f32_16x16x32_bf16 v[120:123], v[232:235], v[56:59], 0
    v_mfma_f32_16x16x32_bf16 v[124:127], v[232:235], v[60:63], 0
    v_mfma_f32_16x16x32_bf16 v[128:131], v[232:235], v[64:67], 0
    v_mfma_f32_16x16x32_bf16 v[132:135], v[232:235], v[68:71], 0
    v_mfma_f32_16x16x32_bf16 v[136:139], v[232:235], v[72:75], 0
    s_waitcnt lgkmcnt(0)
    v_mfma_f32_16x16x32_bf16 v[108:111], v[12:15], v[44:47], v[108:111]
    ds_read_b128 v[200:203], v11 offset:128
    v_mfma_f32_16x16x32_bf16 v[112:115], v[12:15], v[48:51], v[112:115]
    ds_read_b128 v[204:207], v11 offset:640
    v_mfma_f32_16x16x32_bf16 v[116:119], v[12:15], v[52:55], v[116:119]
    ds_read_b128 v[208:211], v11 offset:1152
    v_mfma_f32_16x16x32_bf16 v[120:123], v[12:15], v[56:59], v[120:123]
    ds_read_b128 v[212:215], v11 offset:1664
    v_mfma_f32_16x16x32_bf16 v[124:127], v[12:15], v[60:63], v[124:127]
    ds_read_b128 v[216:219], v11 offset:2176
    v_mfma_f32_16x16x32_bf16 v[128:131], v[12:15], v[64:67], v[128:131]
    ds_read_b128 v[220:223], v11 offset:2688
    v_mfma_f32_16x16x32_bf16 v[132:135], v[12:15], v[68:71], v[132:135]
    ds_read_b128 v[224:227], v11 offset:3200
    v_mfma_f32_16x16x32_bf16 v[136:139], v[12:15], v[72:75], v[136:139]
    ds_read_b128 v[228:231], v11 offset:3712
    v_mfma_f32_16x16x32_bf16 v[112:115], v[16:19], v[44:47], v[112:115]
    ds_read_b64 v[168:169], v10 offset:64
    v_mfma_f32_16x16x32_bf16 v[116:119], v[16:19], v[48:51], v[116:119]
    ds_read_b64 v[170:171], v10 offset:72
    v_mfma_f32_16x16x32_bf16 v[120:123], v[16:19], v[52:55], v[120:123]
    ds_read_b64 v[172:173], v10 offset:576
    v_mfma_f32_16x16x32_bf16 v[124:127], v[16:19], v[56:59], v[124:127]
    ds_read_b64 v[174:175], v10 offset:584
    v_mfma_f32_16x16x32_bf16 v[128:131], v[16:19], v[60:63], v[128:131]
    ds_read_b64 v[176:177], v10 offset:1088
    v_mfma_f32_16x16x32_bf16 v[132:135], v[16:19], v[64:67], v[132:135]
    ds_read_b64 v[178:179], v10 offset:1096
    v_mfma_f32_16x16x32_bf16 v[136:139], v[16:19], v[68:71], v[136:139]
    ds_read_b64 v[180:181], v10 offset:1600
    v_mfma_f32_16x16x32_bf16 v[116:119], v[20:23], v[44:47], v[116:119]
    ds_read_b64 v[182:183], v10 offset:1608
    v_mfma_f32_16x16x32_bf16 v[120:123], v[20:23], v[48:51], v[120:123]
    ds_read_b64 v[184:185], v10 offset:2112
    v_mfma_f32_16x16x32_bf16 v[124:127], v[20:23], v[52:55], v[124:127]
    ds_read_b64 v[186:187], v10 offset:2120
    v_mfma_f32_16x16x32_bf16 v[128:131], v[20:23], v[56:59], v[128:131]
    ds_read_b64 v[188:189], v10 offset:2624
    v_mfma_f32_16x16x32_bf16 v[132:135], v[20:23], v[60:63], v[132:135]
    s_cmp_lg_u32 s53, 0
    s_cbranch_scc1 recurrent_scan__ssm_conv_h3__glu_gated_bilinear__prompt_kernel_hp14
    s_setprio 3
    s_waitcnt vmcnt(0)
    v_mov_b32 v250, s48
    v_mov_b32 v251, s49
    v_lshlrev_b32 v252, 3, v0
    s_mov_b64 exec, 0xffff
    buffer_store_dwordx2 v[250:251], v252, s[40:43], s69 offen sc1
    s_mov_b64 exec, -1
    s_setprio 1
recurrent_scan__ssm_conv_h3__glu_gated_bilinear__prompt_kernel_hp14:
    ds_read_b64 v[190:191], v10 offset:2632
    v_mfma_f32_16x16x32_bf16 v[136:139], v[20:23], v[64:67], v[136:139]
    ds_read_b64 v[192:193], v10 offset:3136
    v_mfma_f32_16x16x32_bf16 v[120:123], v[24:27], v[44:47], v[120:123]
    ds_read_b64 v[194:195], v10 offset:3144
    v_mfma_f32_16x16x32_bf16 v[124:127], v[24:27], v[48:51], v[124:127]
    ds_read_b64 v[196:197], v10 offset:3648
    v_mfma_f32_16x16x32_bf16 v[128:131], v[24:27], v[52:55], v[128:131]
    ds_read_b64 v[198:199], v10 offset:3656
    v_mfma_f32_16x16x32_bf16 v[132:135], v[24:27], v[56:59], v[132:135]
    v_mfma_f32_16x16x32_bf16 v[136:139], v[24:27], v[60:63], v[136:139]
    v_mfma_f32_16x16x32_bf16 v[124:127], v[28:31], v[44:47], v[124:127]
    v_mfma_f32_16x16x32_bf16 v[128:131], v[28:31], v[48:51], v[128:131]
    v_mfma_f32_16x16x32_bf16 v[132:135], v[28:31], v[52:55], v[132:135]
    v_mfma_f32_16x16x32_bf16 v[136:139], v[28:31], v[56:59], v[136:139]
    v_mfma_f32_16x16x32_bf16 v[128:131], v[32:35], v[44:47], v[128:131]
    v_mfma_f32_16x16x32_bf16 v[132:135], v[32:35], v[48:51], v[132:135]
    v_mfma_f32_16x16x32_bf16 v[136:139], v[32:35], v[52:55], v[136:139]
    v_mfma_f32_16x16x32_bf16 v[132:135], v[36:39], v[44:47], v[132:135]
    v_mfma_f32_16x16x32_bf16 v[136:139], v[36:39], v[48:51], v[136:139]
    v_mfma_f32_16x16x32_bf16 v[136:139], v[40:43], v[44:47], v[136:139]
    s_waitcnt lgkmcnt(0)
    v_mfma_f32_16x16x32_bf16 v[108:111], v[168:171], v[200:203], v[108:111]
    ds_read_b128 v[44:47], v11 offset:64
    v_mfma_f32_16x16x32_bf16 v[112:115], v[168:171], v[204:207], v[112:115]
    ds_read_b128 v[48:51], v11 offset:576
    v_mfma_f32_16x16x32_bf16 v[116:119], v[168:171], v[208:211], v[116:119]
    ds_read_b128 v[52:55], v11 offset:1088
    v_mfma_f32_16x16x32_bf16 v[120:123], v[168:171], v[212:215], v[120:123]
    ds_read_b128 v[56:59], v11 offset:1600
    v_mfma_f32_16x16x32_bf16 v[124:127], v[168:171], v[216:219], v[124:127]
    ds_read_b128 v[60:63], v11 offset:2112
    v_mfma_f32_16x16x32_bf16 v[128:131], v[168:171], v[220:223], v[128:131]
    ds_read_b128 v[64:67], v11 offset:2624
    v_mfma_f32_16x16x32_bf16 v[132:135], v[168:171], v[224:227], v[132:135]
    ds_read_b128 v[68:71], v11 offset:3136
    v_mfma_f32_16x16x32_bf16 v[136:139], v[168:171], v[228:231], v[136:139]
    ds_read_b128 v[72:75], v11 offset:3648
    v_mfma_f32_16x16x32_bf16 v[112:115], v[172:175], v[200:203], v[112:115]
    ds_read_b64 v[12:13], v10 offset:128
    v_mfma_f32_16x16x32_bf16 v[116:119], v[172:175], v[204:207], v[116:119]
    ds_read_b64 v[14:15], v10 offset:136
    v_mfma_f32_16x16x32_bf16 v[120:123], v[172:175], v[208:211], v[120:123]
    ds_read_b64 v[16:17], v10 offset:640
    v_mfma_f32_16x16x32_bf16 v[124:127], v[172:175], v[212:215], v[124:127]
    ds_read_b64 v[18:19], v10 offset:648
    v_mfma_f32_16x16x32_bf16 v[128:131], v[172:175], v[216:219], v[128:131]
    ds_read_b64 v[20:21], v10 offset:1152
    v_mfma_f32_16x16x32_bf16 v[132:135], v[172:175], v[220:223], v[132:135]
    ds_read_b64 v[22:23], v10 offset:1160
    v_mfma_f32_16x16x32_bf16 v[136:139], v[172:175], v[224:227], v[136:139]
    ds_read_b64 v[24:25], v10 offset:1664
    v_mfma_f32_16x16x32_bf16 v[116:119], v[176:179], v[200:203], v[116:119]
    ds_read_b64 v[26:27], v10 offset:1672
    v_mfma_f32_16x16x32_bf16 v[120:123], v[176:179], v[204:207], v[120:123]
    ds_read_b64 v[28:29], v10 offset:2176
    v_mfma_f32_16x16x32_bf16 v[124:127], v[176:179], v[208:211], v[124:127]
    ds_read_b64 v[30:31], v10 offset:2184
    v_mfma_f32_16x16x32_bf16 v[128:131], v[176:179], v[212:215], v[128:131]
    ds_read_b64 v[32:33], v10 offset:2688
    v_mfma_f32_16x16x32_bf16 v[132:135], v[176:179], v[216:219], v[132:135]
    ds_read_b64 v[34:35], v10 offset:2696
    v_mfma_f32_16x16x32_bf16 v[136:139], v[176:179], v[220:223], v[136:139]
    ds_read_b64 v[36:37], v10 offset:3200
    v_mfma_f32_16x16x32_bf16 v[120:123], v[180:183], v[200:203], v[120:123]
    ds_read_b64 v[38:39], v10 offset:3208
    v_mfma_f32_16x16x32_bf16 v[124:127], v[180:183], v[204:207], v[124:127]
    ds_read_b64 v[40:41], v10 offset:3712
    v_mfma_f32_16x16x32_bf16 v[128:131], v[180:183], v[208:211], v[128:131]
    ds_read_b64 v[42:43], v10 offset:3720
    v_mfma_f32_16x16x32_bf16 v[132:135], v[180:183], v[212:215], v[132:135]
    v_lshrrev_b32 v5, 5, v0
    v_xor_b32 v6, 1, v5
    v_mfma_f32_16x16x32_bf16 v[136:139], v[180:183], v[216:219], v[136:139]
    v_mul_u32_u24 v5, 0x1ffff, v5
    v_or_b32 v5, 0xfffe0000, v5
    v_mfma_f32_16x16x32_bf16 v[124:127], v[184:187], v[200:203], v[124:127]
    v_lshlrev_b32 v6, 16, v6
    s_lshl3_add_u32 s62, s55, s44
    v_mfma_f32_16x16x32_bf16 v[128:131], v[184:187], v[204:207], v[128:131]
    s_lshl_b32 s62, s62, 3
    v_lshrrev_b32 v76, 3, v0
    v_mfma_f32_16x16x32_bf16 v[132:135], v[184:187], v[208:211], v[132:135]
    v_and_b32 v77, 7, v0
    v_add_u32 v249, s62, v76
    v_mfma_f32_16x16x32_bf16 v[136:139], v[184:187], v[212:215], v[136:139]
    v_lshlrev_b32 v248, 4, v77
    v_lshl_add_u32 v248, v249, 10, v248
    v_mfma_f32_16x16x32_bf16 v[128:131], v[188:191], v[200:203], v[128:131]
    s_lshl_b32 s62, s56, 7
    v_add_u32 v248, s62, v248
    v_mfma_f32_16x16x32_bf16 v[132:135], v[188:191], v[204:207], v[132:135]
    v_lshlrev_b32 v249, 4, v249
    v_add_u32 v249, 65536, v249
    v_mfma_f32_16x16x32_bf16 v[136:139], v[188:191], v[208:211], v[136:139]
    v_mfma_f32_16x16x32_bf16 v[132:135], v[192:195], v[200:203], v[132:135]
    v_mfma_f32_16x16x32_bf16 v[136:139], v[192:195], v[204:207], v[136:139]
    v_mfma_f32_16x16x32_bf16 v[136:139], v[196:199], v[200:203], v[136:139]
    s_waitcnt lgkmcnt(0)
    v_mfma_f32_16x16x32_bf16 v[108:111], v[12:15], v[44:47], v[108:111]
    ds_read_b128 v[200:203], v11 offset:0
    v_mfma_f32_16x16x32_bf16 v[112:115], v[12:15], v[48:51], v[112:115]
    ds_read_b128 v[204:207], v11 offset:512
    v_mfma_f32_16x16x32_bf16 v[116:119], v[12:15], v[52:55], v[116:119]
    ds_read_b128 v[208:211], v11 offset:1024
    v_mfma_f32_16x16x32_bf16 v[120:123], v[12:15], v[56:59], v[120:123]
    ds_read_b128 v[212:215], v11 offset:1536
    v_mfma_f32_16x16x32_bf16 v[124:127], v[12:15], v[60:63], v[124:127]
    ds_read_b128 v[216:219], v11 offset:2048
    v_mfma_f32_16x16x32_bf16 v[128:131], v[12:15], v[64:67], v[128:131]
    ds_read_b128 v[220:223], v11 offset:2560
    v_mfma_f32_16x16x32_bf16 v[132:135], v[12:15], v[68:71], v[132:135]
    ds_read_b128 v[224:227], v11 offset:3072
    v_mfma_f32_16x16x32_bf16 v[136:139], v[12:15], v[72:75], v[136:139]
    ds_read_b128 v[228:231], v11 offset:3584
    v_mfma_f32_16x16x32_bf16 v[112:115], v[16:19], v[44:47], v[112:115]
    ds_read_b64 v[168:169], v10 offset:192
    v_mfma_f32_16x16x32_bf16 v[116:119], v[16:19], v[48:51], v[116:119]
    ds_read_b64 v[170:171], v10 offset:200
    v_mfma_f32_16x16x32_bf16 v[120:123], v[16:19], v[52:55], v[120:123]
    ds_read_b64 v[172:173], v10 offset:704
    v_mfma_f32_16x16x32_bf16 v[124:127], v[16:19], v[56:59], v[124:127]
    ds_read_b64 v[174:175], v10 offset:712
    v_mfma_f32_16x16x32_bf16 v[128:131], v[16:19], v[60:63], v[128:131]
    ds_read_b64 v[176:177], v10 offset:1216
    v_mfma_f32_16x16x32_bf16 v[132:135], v[16:19], v[64:67], v[132:135]
    ds_read_b64 v[178:179], v10 offset:1224
    v_mfma_f32_16x16x32_bf16 v[136:139], v[16:19], v[68:71], v[136:139]
    ds_read_b64 v[180:181], v10 offset:1728
    v_mfma_f32_16x16x32_bf16 v[116:119], v[20:23], v[44:47], v[116:119]
    ds_read_b64 v[182:183], v10 offset:1736
    v_mfma_f32_16x16x32_bf16 v[120:123], v[20:23], v[48:51], v[120:123]
    ds_read_b64 v[184:185], v10 offset:2240
    v_mfma_f32_16x16x32_bf16 v[124:127], v[20:23], v[52:55], v[124:127]
    ds_read_b64 v[186:187], v10 offset:2248
    v_mfma_f32_16x16x32_bf16 v[128:131], v[20:23], v[56:59], v[128:131]
    ds_read_b64 v[188:189], v10 offset:2752
    v_mfma_f32_16x16x32_bf16 v[132:135], v[20:23], v[60:63], v[132:135]
    ds_read_b64 v[190:191], v10 offset:2760
    v_mfma_f32_16x16x32_bf16 v[136:139], v[20:23], v[64:67], v[136:139]
    ds_read_b64 v[192:193], v10 offset:3264
    v_mfma_f32_16x16x32_bf16 v[120:123], v[24:27], v[44:47], v[120:123]
    ds_read_b64 v[194:195], v10 offset:3272
    v_mfma_f32_16x16x32_bf16 v[124:127], v[24:27], v[48:51], v[124:127]
    ds_read_b64 v[196:197], v10 offset:3776
    v_mfma_f32_16x16x32_bf16 v[128:131], v[24:27], v[52:55], v[128:131]
    ds_read_b64 v[198:199], v10 offset:3784
    v_mfma_f32_16x16x32_bf16 v[132:135], v[24:27], v[56:59], v[132:135]
    s_lshr_b32 s62, s47, 1
    s_and_b32 s63, s47, 1
    v_mfma_f32_16x16x32_bf16 v[136:139], v[24:27], v[60:63], v[136:139]
    s_mul_i32 s64, s62, 16640
    s_add_u32 s64, s64, 130624
    v_mfma_f32_16x16x32_bf16 v[124:127], v[28:31], v[44:47], v[124:127]
    v_lshrrev_b32 v1, 3, v0
    v_and_b32 v3, 0x70, v8
    v_mfma_f32_16x16x32_bf16 v[128:131], v[28:31], v[48:51], v[128:131]
    v_lshl_add_u32 v1, v1, 9, v3
    v_add_u32 v1, s64, v1
    v_mfma_f32_16x16x32_bf16 v[132:135], v[28:31], v[52:55], v[132:135]
    v_mov_b32 v4, 1
    s_lshl_b32 s64, s45, 5
    v_mfma_f32_16x16x32_bf16 v[136:139], v[28:31], v[56:59], v[136:139]
    s_add_u32 s64, s64, s46
    s_lshl1_add_u32 s64, s64, s62
    v_mfma_f32_16x16x32_bf16 v[128:131], v[32:35], v[44:47], v[128:131]
    s_lshl3_add_u32 s65, s64, s63
    s_lshl_b32 s65, s65, 9
    v_mfma_f32_16x16x32_bf16 v[132:135], v[32:35], v[48:51], v[132:135]
    s_add_u32 s65, s65, 1048576
    v_lshrrev_b32 v2, 5, v0
    v_mfma_f32_16x16x32_bf16 v[136:139], v[32:35], v[52:55], v[136:139]
    v_lshlrev_b32 v2, 10, v2
    v_bfe_u32 v3, v0, 2, 2
    v_mfma_f32_16x16x32_bf16 v[132:135], v[36:39], v[44:47], v[132:135]
    v_lshl_add_u32 v2, v3, 7, v2
    v_bfe_u32 v3, v0, 4, 1
    v_mfma_f32_16x16x32_bf16 v[136:139], v[36:39], v[48:51], v[136:139]
    v_lshl_add_u32 v2, v3, 6, v2
    v_and_b32 v3, 48, v8
    v_mfma_f32_16x16x32_bf16 v[136:139], v[40:43], v[44:47], v[136:139]
    v_add_u32 v2, v3, v2
    s_cmp_eq_u32 s63, 1
    s_setprio 3
    buffer_load_dwordx4 v[240:243], v248, s[4:7], 0 offen
    buffer_load_dwordx4 v[244:247], v249, s[40:43], 0 offen sc1
    s_setprio 1
    s_waitcnt lgkmcnt(0)
    s_cbranch_scc1 recurrent_scan__ssm_conv_h3__glu_gated_bilinear__prompt_kernel_xh1
    v_mfma_f32_16x16x32_bf16 v[112:115], v[168:171], v[204:207], v[112:115]
    v_mfma_f32_16x16x32_bf16 v[120:123], v[168:171], v[212:215], v[120:123]
    v_mfma_f32_16x16x32_bf16 v[128:131], v[168:171], v[220:223], v[128:131]
    v_mfma_f32_16x16x32_bf16 v[136:139], v[168:171], v[228:231], v[136:139]
    v_mfma_f32_16x16x32_bf16 v[112:115], v[172:175], v[200:203], v[112:115]
    v_mfma_f32_16x16x32_bf16 v[120:123], v[172:175], v[208:211], v[120:123]
    v_mfma_f32_16x16x32_bf16 v[128:131], v[172:175], v[216:219], v[128:131]
    v_mfma_f32_16x16x32_bf16 v[136:139], v[172:175], v[224:227], v[136:139]
    v_mfma_f32_16x16x32_bf16 v[120:123], v[176:179], v[204:207], v[120:123]
    v_mfma_f32_16x16x32_bf16 v[128:131], v[176:179], v[212:215], v[128:131]
    v_mfma_f32_16x16x32_bf16 v[136:139], v[176:179], v[220:223], v[136:139]
    v_mfma_f32_16x16x32_bf16 v[120:123], v[180:183], v[200:203], v[120:123]
    v_mfma_f32_16x16x32_bf16 v[128:131], v[180:183], v[208:211], v[128:131]
    v_mfma_f32_16x16x32_bf16 v[136:139], v[180:183], v[216:219], v[136:139]
    v_mfma_f32_16x16x32_bf16 v[128:131], v[184:187], v[204:207], v[128:131]
    v_mfma_f32_16x16x32_bf16 v[136:139], v[184:187], v[212:215], v[136:139]
    v_mfma_f32_16x16x32_bf16 v[128:131], v[188:191], v[200:203], v[128:131]
    v_mfma_f32_16x16x32_bf16 v[136:139], v[188:191], v[208:211], v[136:139]
    v_mfma_f32_16x16x32_bf16 v[136:139], v[192:195], v[204:207], v[136:139]
    v_mfma_f32_16x16x32_bf16 v[136:139], v[196:199], v[200:203], v[136:139]
    v_mfma_f32_16x16x32_bf16 v[108:111], v[168:171], v[200:203], v[108:111]
    v_mfma_f32_16x16x32_bf16 v[116:119], v[168:171], v[208:211], v[116:119]
    v_mfma_f32_16x16x32_bf16 v[124:127], v[168:171], v[216:219], v[124:127]
    v_mfma_f32_16x16x32_bf16 v[132:135], v[168:171], v[224:227], v[132:135]
    ds_write_b128 v1, v[112:115] offset:0
    v_mfma_f32_16x16x32_bf16 v[116:119], v[172:175], v[204:207], v[116:119]
    ds_write_b128 v1, v[120:123] offset:4160
    v_mfma_f32_16x16x32_bf16 v[124:127], v[172:175], v[212:215], v[124:127]
    ds_write_b128 v1, v[128:131] offset:8320
    v_mfma_f32_16x16x32_bf16 v[132:135], v[172:175], v[220:223], v[132:135]
    ds_write_b128 v1, v[136:139] offset:12480
    v_mfma_f32_16x16x32_bf16 v[116:119], v[176:179], v[200:203], v[116:119]
    v_mfma_f32_16x16x32_bf16 v[124:127], v[176:179], v[208:211], v[124:127]
    v_mfma_f32_16x16x32_bf16 v[132:135], v[176:179], v[216:219], v[132:135]
    v_mfma_f32_16x16x32_bf16 v[124:127], v[180:183], v[204:207], v[124:127]
    v_mfma_f32_16x16x32_bf16 v[132:135], v[180:183], v[212:215], v[132:135]
    v_mfma_f32_16x16x32_bf16 v[124:127], v[184:187], v[200:203], v[124:127]
    s_waitcnt lgkmcnt(0)
    ds_write_b32 v255, v4 offset:4160
    v_mfma_f32_16x16x32_bf16 v[132:135], v[184:187], v[208:211], v[132:135]
    v_mfma_f32_16x16x32_bf16 v[132:135], v[188:191], v[204:207], v[132:135]
    v_mfma_f32_16x16x32_bf16 v[132:135], v[192:195], v[200:203], v[132:135]
    s_setprio 3
    s_mov_b32 s57, 3200000
recurrent_scan__ssm_conv_h3__glu_gated_bilinear__prompt_kernel_xl15:
    ds_read_b32 v16, v254 offset:4160
    s_waitcnt lgkmcnt(0)
    v_cmp_ne_u32 vcc, 1, v16
    s_nop 1
    s_cmp_eq_u64 vcc, 0
    s_cbranch_scc1 recurrent_scan__ssm_conv_h3__glu_gated_bilinear__prompt_kernel_xd16
    s_sleep 1
    s_sub_u32 s57, s57, 1
    s_cbranch_scc0 recurrent_scan__ssm_conv_h3__glu_gated_bilinear__prompt_kernel_xl15
recurrent_scan__ssm_conv_h3__glu_gated_bilinear__prompt_kernel_xd16:
    ds_read_b128 v[16:19], v1 offset:256
    ds_read_b128 v[20:23], v1 offset:4416
    ds_read_b128 v[24:27], v1 offset:8576
    ds_read_b128 v[28:31], v1 offset:12736
    s_waitcnt lgkmcnt(3)
    v_add_f32 v16, v16, v108
    v_add_f32 v17, v17, v109
    v_add_f32 v18, v18, v110
    v_add_f32 v19, v19, v111
    s_waitcnt lgkmcnt(2)
    v_add_f32 v20, v20, v116
    v_add_f32 v21, v21, v117
    v_add_f32 v22, v22, v118
    v_add_f32 v23, v23, v119
    s_waitcnt lgkmcnt(1)
    v_add_f32 v24, v24, v124
    v_add_f32 v25, v25, v125
    v_add_f32 v26, v26, v126
    v_add_f32 v27, v27, v127
    s_waitcnt lgkmcnt(0)
    v_add_f32 v28, v28, v132
    v_add_f32 v29, v29, v133
    v_add_f32 v30, v30, v134
    v_add_f32 v31, v31, v135
    s_branch recurrent_scan__ssm_conv_h3__glu_gated_bilinear__prompt_kernel_xj
recurrent_scan__ssm_conv_h3__glu_gated_bilinear__prompt_kernel_xh1:
    v_mfma_f32_16x16x32_bf16 v[108:111], v[168:171], v[200:203], v[108:111]
    v_mfma_f32_16x16x32_bf16 v[116:119], v[168:171], v[208:211], v[116:119]
    v_mfma_f32_16x16x32_bf16 v[124:127], v[168:171], v[216:219], v[124:127]
    v_mfma_f32_16x16x32_bf16 v[132:135], v[168:171], v[224:227], v[132:135]
    v_mfma_f32_16x16x32_bf16 v[116:119], v[172:175], v[204:207], v[116:119]
    v_mfma_f32_16x16x32_bf16 v[124:127], v[172:175], v[212:215], v[124:127]
    v_mfma_f32_16x16x32_bf16 v[132:135], v[172:175], v[220:223], v[132:135]
    v_mfma_f32_16x16x32_bf16 v[116:119], v[176:179], v[200:203], v[116:119]
    v_mfma_f32_16x16x32_bf16 v[124:127], v[176:179], v[208:211], v[124:127]
    v_mfma_f32_16x16x32_bf16 v[132:135], v[176:179], v[216:219], v[132:135]
    v_mfma_f32_16x16x32_bf16 v[124:127], v[180:183], v[204:207], v[124:127]
    v_mfma_f32_16x16x32_bf16 v[132:135], v[180:183], v[212:215], v[132:135]
    v_mfma_f32_16x16x32_bf16 v[124:127], v[184:187], v[200:203], v[124:127]
    v_mfma_f32_16x16x32_bf16 v[132:135], v[184:187], v[208:211], v[132:135]
    v_mfma_f32_16x16x32_bf16 v[132:135], v[188:191], v[204:207], v[132:135]
    v_mfma_f32_16x16x32_bf16 v[132:135], v[192:195], v[200:203], v[132:135]
    v_mfma_f32_16x16x32_bf16 v[112:115], v[168:171], v[204:207], v[112:115]
    v_mfma_f32_16x16x32_bf16 v[120:123], v[168:171], v[212:215], v[120:123]
    v_mfma_f32_16x16x32_bf16 v[128:131], v[168:171], v[220:223], v[128:131]
    v_mfma_f32_16x16x32_bf16 v[136:139], v[168:171], v[228:231], v[136:139]
    ds_write_b128 v1, v[108:111] offset:256
    v_mfma_f32_16x16x32_bf16 v[112:115], v[172:175], v[200:203], v[112:115]
    ds_write_b128 v1, v[116:119] offset:4416
    v_mfma_f32_16x16x32_bf16 v[120:123], v[172:175], v[208:211], v[120:123]
    ds_write_b128 v1, v[124:127] offset:8576
    v_mfma_f32_16x16x32_bf16 v[128:131], v[172:175], v[216:219], v[128:131]
    ds_write_b128 v1, v[132:135] offset:12736
    v_mfma_f32_16x16x32_bf16 v[136:139], v[172:175], v[224:227], v[136:139]
    v_mfma_f32_16x16x32_bf16 v[120:123], v[176:179], v[204:207], v[120:123]
    v_mfma_f32_16x16x32_bf16 v[128:131], v[176:179], v[212:215], v[128:131]
    v_mfma_f32_16x16x32_bf16 v[136:139], v[176:179], v[220:223], v[136:139]
    v_mfma_f32_16x16x32_bf16 v[120:123], v[180:183], v[200:203], v[120:123]
    v_mfma_f32_16x16x32_bf16 v[128:131], v[180:183], v[208:211], v[128:131]
    s_waitcnt lgkmcnt(0)
    ds_write_b32 v255, v4 offset:4160
    v_mfma_f32_16x16x32_bf16 v[136:139], v[180:183], v[216:219], v[136:139]
    v_mfma_f32_16x16x32_bf16 v[128:131], v[184:187], v[204:207], v[128:131]
    v_mfma_f32_16x16x32_bf16 v[136:139], v[184:187], v[212:215], v[136:139]
    v_mfma_f32_16x16x32_bf16 v[128:131], v[188:191], v[200:203], v[128:131]
    v_mfma_f32_16x16x32_bf16 v[136:139], v[188:191], v[208:211], v[136:139]
    v_mfma_f32_16x16x32_bf16 v[136:139], v[192:195], v[204:207], v[136:139]
    v_mfma_f32_16x16x32_bf16 v[136:139], v[196:199], v[200:203], v[136:139]
    s_setprio 3
    s_mov_b32 s57, 3200000
recurrent_scan__ssm_conv_h3__glu_gated_bilinear__prompt_kernel_xl17:
    ds_read_b32 v16, v254 offset:4160
    s_waitcnt lgkmcnt(0)
    v_cmp_ne_u32 vcc, 1, v16
    s_nop 1
    s_cmp_eq_u64 vcc, 0
    s_cbranch_scc1 recurrent_scan__ssm_conv_h3__glu_gated_bilinear__prompt_kernel_xd18
    s_sleep 1
    s_sub_u32 s57, s57, 1
    s_cbranch_scc0 recurrent_scan__ssm_conv_h3__glu_gated_bilinear__prompt_kernel_xl17
recurrent_scan__ssm_conv_h3__glu_gated_bilinear__prompt_kernel_xd18:
    ds_read_b128 v[16:19], v1 offset:0
    ds_read_b128 v[20:23], v1 offset:4160
    ds_read_b128 v[24:27], v1 offset:8320
    ds_read_b128 v[28:31], v1 offset:12480
    s_waitcnt lgkmcnt(3)
    v_add_f32 v16, v16, v112
    v_add_f32 v17, v17, v113
    v_add_f32 v18, v18, v114
    v_add_f32 v19, v19, v115
    s_waitcnt lgkmcnt(2)
    v_add_f32 v20, v20, v120
    v_add_f32 v21, v21, v121
    v_add_f32 v22, v22, v122
    v_add_f32 v23, v23, v123
    s_waitcnt lgkmcnt(1)
    v_add_f32 v24, v24, v128
    v_add_f32 v25, v25, v129
    v_add_f32 v26, v26, v130
    v_add_f32 v27, v27, v131
    s_waitcnt lgkmcnt(0)
    v_add_f32 v28, v28, v136
    v_add_f32 v29, v29, v137
    v_add_f32 v30, v30, v138
    v_add_f32 v31, v31, v139
recurrent_scan__ssm_conv_h3__glu_gated_bilinear__prompt_kernel_xj:
    v_and_or_b32 v16, v16, v5, v6
    v_and_or_b32 v20, v20, v5, v6
    v_cvt_pk_bf16_f32 v32, v16, v17
    v_cvt_pk_bf16_f32 v33, v18, v19
    v_cvt_pk_bf16_f32 v34, v20, v21
    v_cvt_pk_bf16_f32 v35, v22, v23
    s_nop 0
    v_permlane32_swap_b32 v32, v34
    v_permlane32_swap_b32 v33, v35
    v_or_b32 v32, 1, v32
    buffer_store_dwordx4 v[32:35], v2, s[40:43], s65 offen offset:0 sc1
    v_and_or_b32 v24, v24, v5, v6
    v_and_or_b32 v28, v28, v5, v6
    v_cvt_pk_bf16_f32 v36, v24, v25
    v_cvt_pk_bf16_f32 v37, v26, v27
    v_cvt_pk_bf16_f32 v38, v28, v29
    v_cvt_pk_bf16_f32 v39, v30, v31
    s_nop 0
    v_permlane32_swap_b32 v36, v38
    v_permlane32_swap_b32 v37, v39
    v_or_b32 v36, 1, v36
    buffer_store_dwordx4 v[36:39], v2, s[40:43], s65 offen offset:2048 sc1
    v_lshrrev_b32 v4, 3, v0
    v_and_b32 v5, 7, v0
    s_lshr_b32 s62, s44, 2
    s_mul_i32 s62, s62, 40960
    s_lshl_b32 s63, s47, 11
    s_add_u32 s62, s62, s63
    v_lshlrev_b32 v6, 1, v5
    v_xor_b32 v6, v6, v4
    v_lshlrev_b32 v6, 4, v6
    v_lshl_add_u32 v6, v4, 8, v6
    v_add_u32 v224, s62, v6
    v_xor_b32 v225, 16, v224
    v_lshrrev_b32 v6, 2, v5
    v_mul_u32_u24 v226, 4608, v6
    v_bfe_u32 v6, v0, 1, 1
    v_mul_u32_u24 v6, 2176, v6
    v_add_u32 v226, v226, v6
    v_and_b32 v6, 1, v0
    v_lshl_add_u32 v226, v6, 4, v226
    v_lshl_add_u32 v226, v4, 5, v226
    s_lshl_b32 s62, s44, 8
    s_add_u32 s62, s62, 121344
    v_add_u32 v226, s62, v226
    v_mov_b32 v228, 1.0
    s_lshl2_add_u32 s62, s56, s47
    s_lshl_b32 s62, s62, 16
    s_lshl_b32 s63, s55, 7
    s_add_u32 s62, s62, s63
    s_add_u32 s65, s62, 1048576
    s_add_u32 s66, s65, 32768
    v_lshrrev_b32 v13, 3, v0
    v_and_b32 v14, 7, v0
    v_lshlrev_b32 v14, 4, v14
    v_lshl_add_u32 v13, v13, 12, v14
    s_lshr_b32 s62, s47, 1
    s_mul_i32 s62, s62, 4608
    s_and_b32 s63, s47, 1
    s_mul_i32 s63, s63, 2176
    s_add_u32 s62, s62, s63
    s_add_u32 s64, s62, 121344
    v_lshlrev_b32 v14, 4, v0
    v_add_u32 v14, s64, v14
    v_bfe_u32 v15, v0, 2, 2
    v_lshlrev_b32 v15, 7, v15
    v_and_b32 v16, 1, v0
    v_lshl_add_u32 v15, v16, 6, v15
    v_lshrrev_b32 v16, 4, v0
    v_lshl_add_u32 v15, v16, 4, v15
    v_bfe_u32 v16, v0, 1, 1
    v_lshl_add_u32 v15, v16, 3, v15
    v_add_u32 v15, s64, v15
    v_lshlrev_b32 v16, 5, v0
    v_add_u32 v16, s64, v16
    s_waitcnt vmcnt(2)
    s_mov_b32 s57, 400000
    s_branch recurrent_scan__ssm_conv_h3__glu_gated_bilinear__prompt_kernel_pc20
recurrent_scan__ssm_conv_h3__glu_gated_bilinear__prompt_kernel_pl19:
    buffer_load_dwordx4 v[244:247], v249, s[40:43], 0 offen sc1
    s_waitcnt vmcnt(0)
recurrent_scan__ssm_conv_h3__glu_gated_bilinear__prompt_kernel_pc20:
    v_cmp_ne_u32 vcc, s48, v246
    v_cmp_ne_u32 s[58:59], s49, v247
    s_nop 1
    s_or_b64 vcc, vcc, s[58:59]
    s_cbranch_scc0 recurrent_scan__ssm_conv_h3__glu_gated_bilinear__prompt_kernel_pd21
    s_sleep 2
    s_sub_u32 s57, s57, 1
    s_cbranch_scc0 recurrent_scan__ssm_conv_h3__glu_gated_bilinear__prompt_kernel_pl19
recurrent_scan__ssm_conv_h3__glu_gated_bilinear__prompt_kernel_pd21:
    s_mov_b32 s74, 0xffff0000
    v_lshlrev_b32 v208, 16, v240
    v_and_b32 v209, s74, v240
    v_lshlrev_b32 v210, 16, v241
    v_and_b32 v211, s74, v241
    v_lshlrev_b32 v212, 16, v242
    v_and_b32 v213, s74, v242
    v_lshlrev_b32 v214, 16, v243
    v_and_b32 v215, s74, v243
    v_mul_f32 v246, v245, v245
    v_mul_f32 v247, v246, v245
    v_mul_f32 v246, 0xbfb8aa3b, v246
    v_sub_f32 v216, v208, v244
    v_sub_f32 v217, v209, v244
    v_sub_f32 v218, v210, v244
    v_sub_f32 v219, v211, v244
    v_sub_f32 v220, v212, v244
    v_sub_f32 v221, v213, v244
    v_sub_f32 v222, v214, v244
    v_sub_f32 v223, v215, v244
    v_mul_f32 v216, v216, v247
    v_mul_f32 v217, v217, v247
    v_mul_f32 v218, v218, v247
    v_mul_f32 v219, v219, v247
    v_mul_f32 v220, v220, v247
    v_mul_f32 v221, v221, v247
    v_mul_f32 v222, v222, v247
    v_mul_f32 v223, v223, v247
    s_mov_b32 s57, 3200000
recurrent_scan__ssm_conv_h3__glu_gated_bilinear__prompt_kernel_xl22:
    ds_read_b32 v18, v255 offset:4176
    s_waitcnt lgkmcnt(0)
    v_cmp_ne_u32 vcc, 1, v18
    s_nop 1
    s_cmp_eq_u64 vcc, 0
    s_cbranch_scc1 recurrent_scan__ssm_conv_h3__glu_gated_bilinear__prompt_kernel_xd23
    s_sleep 1
    s_sub_u32 s57, s57, 1
    s_cbranch_scc0 recurrent_scan__ssm_conv_h3__glu_gated_bilinear__prompt_kernel_xl22
recurrent_scan__ssm_conv_h3__glu_gated_bilinear__prompt_kernel_xd23:
    v_and_b32 v17, 11, v0
    v_cmp_eq_u32 vcc, 0, v17
    v_mov_b32 v17, 0x10001
    s_mov_b32 m0, s64
    s_sub_u32 s66, s66, 1024
    v_cndmask_b32 v17, 0, v17, vcc
    s_mov_b32 s57, 400000
recurrent_scan__ssm_conv_h3__glu_gated_bilinear__prompt_kernel_pl24:
    buffer_load_dwordx4 v13, s[40:43], s65 offen sc1 lds
    buffer_load_dwordx4 v13, s[40:43], s66 offen offset:1024 sc1 lds
    s_waitcnt vmcnt(0)
recurrent_scan__ssm_conv_h3__glu_gated_bilinear__prompt_kernel_pc25:
    ds_read_b64_tr_b16 v[28:29], v15 offset:0
    ds_read_b64_tr_b16 v[30:31], v15 offset:512
    ds_read_b64_tr_b16 v[32:33], v15 offset:1024
    ds_read_b64_tr_b16 v[34:35], v15 offset:1536
    s_waitcnt lgkmcnt(0)
    v_and_b32 v20, v28, v29
    v_and_b32 v21, v30, v31
    v_and_b32 v22, v32, v33
    v_and_b32 v23, v34, v35
    v_and_b32 v20, v20, v21
    v_and_b32 v22, v22, v23
    v_and_b32 v20, v20, v22
    v_and_b32 v20, v20, v17
    v_cmp_ne_u32 vcc, v20, v17
    s_nop 1
    s_cmp_lg_u64 vcc, 0
    s_cbranch_scc0 recurrent_scan__ssm_conv_h3__glu_gated_bilinear__prompt_kernel_pd26
    s_sleep 4
    s_sub_u32 s57, s57, 1
    s_cbranch_scc0 recurrent_scan__ssm_conv_h3__glu_gated_bilinear__prompt_kernel_pl24
recurrent_scan__ssm_conv_h3__glu_gated_bilinear__prompt_kernel_pd26:
    s_waitcnt lgkmcnt(0)
    ds_write_b128 v16, v[28:31]
    ds_write_b128 v16, v[32:35] offset:16
    s_branch recurrent_scan__ssm_conv_h3__glu_gated_bilinear__prompt_kernel_final
recurrent_scan__ssm_conv_h3__glu_gated_bilinear__prompt_kernel_grslow:
    s_mov_b32 s57, 400000
recurrent_scan__ssm_conv_h3__glu_gated_bilinear__prompt_kernel_pl27:
    buffer_load_dwordx4 v[164:167], v3, s[40:43], s22 offen offset:0 sc1
    buffer_load_dwordx4 v[168:171], v3, s[40:43], s22 offen offset:2048 sc1
    buffer_load_dwordx4 v[172:175], v3, s[40:43], s22 offen offset:256 sc1
    buffer_load_dwordx4 v[176:179], v3, s[40:43], s22 offen offset:2304 sc1
    buffer_load_dwordx4 v[180:183], v7, s[40:43], 0 offen offset:0 sc1
    buffer_load_dwordx4 v[184:187], v7, s[40:43], 0 offen offset:256 sc1
    buffer_load_dwordx4 v[188:191], v7, s[40:43], 0 offen offset:512 sc1
    buffer_load_dwordx4 v[192:195], v7, s[40:43], 0 offen offset:768 sc1
    s_waitcnt vmcnt(0)
recurrent_scan__ssm_conv_h3__glu_gated_bilinear__prompt_kernel_pc28:
    v_xor_b32 v236, s48, v167
    v_xor_b32 v237, s48, v171
    v_xor_b32 v238, s48, v175
    v_or3_b32 v236, v236, v237, v238
    v_xor_b32 v237, s48, v179
    v_xor_b32 v238, s48, v182
    v_or3_b32 v236, v236, v237, v238
    v_xor_b32 v237, s49, v183
    v_xor_b32 v238, s48, v186
    v_or3_b32 v236, v236, v237, v238
    v_xor_b32 v237, s49, v187
    v_xor_b32 v238, s48, v190
    v_or3_b32 v236, v236, v237, v238
    v_xor_b32 v237, s49, v191
    v_xor_b32 v238, s48, v194
    v_or3_b32 v236, v236, v237, v238
    v_xor_b32 v237, s49, v195
    v_or_b32 v236, v236, v237
    v_cmp_ne_u32 vcc, 0, v236
    s_nop 1
    s_cmp_lg_u64 vcc, 0
    s_cbranch_scc0 recurrent_scan__ssm_conv_h3__glu_gated_bilinear__prompt_kernel_pd29
    s_sleep 2
    s_sub_u32 s57, s57, 1
    s_cbranch_scc0 recurrent_scan__ssm_conv_h3__glu_gated_bilinear__prompt_kernel_pl27
recurrent_scan__ssm_conv_h3__glu_gated_bilinear__prompt_kernel_pd29:
    s_branch recurrent_scan__ssm_conv_h3__glu_gated_bilinear__prompt_kernel_grok
recurrent_scan__ssm_conv_h3__glu_gated_bilinear__prompt_kernel_Lspare:
    s_mov_b32 s22, 2097152
    s_mov_b32 s23, s3
    s_mov_b64 s[20:21], s[84:85]
    s_mov_b32 s34, 1409024
    s_mov_b32 s35, s3
    s_mov_b64 s[32:33], s[94:95]
    v_lshlrev_b32 v1, 7, v0
    s_mul_i32 s63, s45, 43
    s_lshr_b32 s63, s63, 1
    s_and_b32 s62, s46, 1
    s_lshl2_add_u32 s62, s62, s47
    s_add_u32 s69, s62, s63
    s_lshl_b32 s63, s45, 5
    s_add_u32 s70, s62, s63
    s_lshl_b32 s70, s70, 13
    s_lshl3_add_u32 s71, s45, s62
    s_lshl_b32 s71, s71, 13
    s_cmp_ge_u32 s69, 172
    s_cselect_b32 s62, 172, 0
    s_sub_u32 s69, s69, s62
    s_lshl_b32 s62, s69, 13
    buffer_load_dword v2, v1, s[32:35], s62 offen
    s_add_u32 s69, s69, 8
    s_cmp_ge_u32 s69, 172
    s_cselect_b32 s62, 172, 0
    s_sub_u32 s69, s69, s62
    s_lshl_b32 s62, s69, 13
    buffer_load_dword v2, v1, s[32:35], s62 offen
    s_add_u32 s69, s69, 8
    s_branch recurrent_scan__ssm_conv_h3__glu_gated_bilinear__prompt_kernel_Lsetup
recurrent_scan__ssm_conv_h3__glu_gated_bilinear__prompt_kernel_wdpf:
    s_barrier
    s_barrier
    s_barrier
    s_cmp_ge_u32 s69, 172
    s_cselect_b32 s62, 172, 0
    s_sub_u32 s69, s69, s62
    s_lshl_b32 s62, s69, 13
    buffer_load_dword v2, v1, s[32:35], s62 offen
    s_add_u32 s69, s69, 8
    s_cmp_ge_u32 s69, 172
    s_cselect_b32 s62, 172, 0
    s_sub_u32 s69, s69, s62
    s_lshl_b32 s62, s69, 13
    buffer_load_dword v2, v1, s[32:35], s62 offen
    s_add_u32 s69, s69, 8
    s_cmp_ge_u32 s69, 172
    s_cselect_b32 s62, 172, 0
    s_sub_u32 s69, s69, s62
    s_lshl_b32 s62, s69, 13
    buffer_load_dword v2, v1, s[32:35], s62 offen
    s_add_u32 s69, s69, 8
    s_cmp_ge_u32 s69, 172
    s_cselect_b32 s62, 172, 0
    s_sub_u32 s69, s69, s62
    s_lshl_b32 s62, s69, 13
    buffer_load_dword v2, v1, s[32:35], s62 offen
    s_add_u32 s69, s69, 8
    buffer_load_dwordx4 v[160:163], v31, s[20:23], 0 offen offset:0
    buffer_load_dwordx2 v[164:165], v31, s[20:23], 0 offen offset:16
    buffer_load_dwordx4 v[168:171], v31, s[20:23], 0 offen offset:1024
    buffer_load_dwordx2 v[172:173], v31, s[20:23], 0 offen offset:1040
    buffer_load_dwordx2 v[28:29], v26, s[40:43], 0 offen sc1
    s_waitcnt vmcnt(0)
    s_branch recurrent_scan__ssm_conv_h3__glu_gated_bilinear__prompt_kernel_Ljoin
recurrent_scan__ssm_conv_h3__glu_gated_bilinear__prompt_kernel_Cspare:
    v_mov_b32 v251, 1
    ds_write_b32 v255, v251 offset:8320
    s_barrier
    s_barrier
    s_or_b32 s62, s51, s47
    s_cbranch_scc1 recurrent_scan__ssm_conv_h3__glu_gated_bilinear__prompt_kernel_Cs4
    v_lshlrev_b32 v12, 7, v0
    v_add_u32 v12, 65544, v12
    v_add_u32 v13, 8192, v12
    v_add_u32 v14, 16384, v12
    v_add_u32 v15, 24576, v12
    s_mov_b32 s57, 400000
recurrent_scan__ssm_conv_h3__glu_gated_bilinear__prompt_kernel_pl30:
    buffer_load_dwordx2 v[18:19], v12, s[40:43], 0 offen sc1
    buffer_load_dwordx2 v[20:21], v13, s[40:43], 0 offen sc1
    buffer_load_dwordx2 v[22:23], v14, s[40:43], 0 offen sc1
    buffer_load_dwordx2 v[24:25], v15, s[40:43], 0 offen sc1
    s_waitcnt vmcnt(0)
recurrent_scan__ssm_conv_h3__glu_gated_bilinear__prompt_kernel_pc31:
    v_cmp_ne_u32 vcc, s48, v18
    v_cmp_ne_u32 s[58:59], s49, v19
    s_nop 1
    s_or_b64 vcc, vcc, s[58:59]
    v_cmp_ne_u32 s[58:59], s48, v20
    s_nop 1
    s_or_b64 vcc, vcc, s[58:59]
    v_cmp_ne_u32 s[58:59], s49, v21
    s_nop 1
    s_or_b64 vcc, vcc, s[58:59]
    v_cmp_ne_u32 s[58:59], s48, v22
    s_nop 1
    s_or_b64 vcc, vcc, s[58:59]
    v_cmp_ne_u32 s[58:59], s49, v23
    s_nop 1
    s_or_b64 vcc, vcc, s[58:59]
    v_cmp_ne_u32 s[58:59], s48, v24
    s_nop 1
    s_or_b64 vcc, vcc, s[58:59]
    v_cmp_ne_u32 s[58:59], s49, v25
    s_nop 1
    s_or_b64 vcc, vcc, s[58:59]
    s_cbranch_scc0 recurrent_scan__ssm_conv_h3__glu_gated_bilinear__prompt_kernel_pd32
    s_sleep 16
    s_sub_u32 s57, s57, 1
    s_cbranch_scc0 recurrent_scan__ssm_conv_h3__glu_gated_bilinear__prompt_kernel_pl30
recurrent_scan__ssm_conv_h3__glu_gated_bilinear__prompt_kernel_pd32:
    v_mov_b32 v12, s48
    s_mov_b64 exec, 1
    buffer_store_dword v12, off, s[40:43], 0 offset:0 sc1
    s_mov_b64 exec, -1
recurrent_scan__ssm_conv_h3__glu_gated_bilinear__prompt_kernel_Cs4:
    s_branch recurrent_scan__ssm_conv_h3__glu_gated_bilinear__prompt_kernel_conv
recurrent_scan__ssm_conv_h3__glu_gated_bilinear__prompt_kernel_end:
    s_endpgm
.section .rodata,"a"
.p2align 6
.amdhsa_kernel recurrent_scan__ssm_conv_h3__glu_gated_bilinear__prompt_kernel
  .amdhsa_next_free_vgpr 256
  .amdhsa_next_free_sgpr 102
  .amdhsa_accum_offset 256
  .amdhsa_group_segment_fixed_size 0
  .amdhsa_kernarg_size 104
  .amdhsa_user_sgpr_count 2
  .amdhsa_user_sgpr_kernarg_segment_ptr 1
  .amdhsa_system_sgpr_workgroup_id_x 1
.end_amdhsa_kernel
```
